```python
import torch

def _softmax(x, axis=-1):
    return torch.softmax(x, dim=axis)
def _gelu(x):
    return torch.nn.functional.gelu(x, approximate="tanh")
def _silu(x):
    return torch.nn.functional.silu(x)
def _sigmoid(x):
    return torch.sigmoid(x)
def _layernorm(x, axis=-1, eps=1e-5):
    m = x.mean(dim=axis, keepdim=True)
    v = x.var(dim=axis, keepdim=True, unbiased=False)
    return (x - m) / torch.sqrt(v + eps)
def _scatter_add(tgt, idx, src, axis=0):
    return tgt.clone().index_add_(axis, idx, src)
def _segment_sum(src, seg, n):
    out = torch.zeros((n,) + src.shape[1:], dtype=src.dtype)
    return out.index_add_(0, seg, src)
def _pad(x, pw):
    flat = tuple(v for pair in reversed(pw) for v in pair)
    return torch.nn.functional.pad(x, flat)

kernel_name = 'sequential_preLN__compressed_kv_cla__glu_gated_reglu__decode'

def setup_inputs():

    _w = (lambda a: (lambda t: t.to(torch.bfloat16) if t.is_floating_point() else t)(torch.as_tensor(a)))
    def _A_setup():
        B, H, Sq, Sk, D, M = 1, 32, 1, 4096, 128, 640
        Dc = 4 * D
        return {
            "x": _w((lambda *s: torch.randn(*s, dtype=torch.bfloat16) * 0.05)(B, Sq, M)),
            "c_kv": _w((lambda *s: torch.randn(*s, dtype=torch.bfloat16) * 0.8)(B, Sk, Dc)),
            "w_q": _w((lambda *s: torch.randn(*s, dtype=torch.bfloat16) * 1.6)(M, H, D) * (M ** -0.5)),
            "w_uk": _w((lambda *s: torch.randn(*s, dtype=torch.bfloat16) * 1.6)(Dc, H, D) * (Dc ** -0.5)),
            "w_uv": _w((lambda *s: torch.randn(*s, dtype=torch.bfloat16) * 0.8)(Dc, H, D) * (Dc ** -0.5)),
            "w_o": _w((lambda *s: torch.randn(*s, dtype=torch.bfloat16) * 0.8)(H, D, M) * ((H * D) ** -0.5)),
        }
    _A_in = _A_setup()

    def _B_setup():
        B, S, D, F = 1, 1, 640, 1728
        return {
            "x": _w((lambda *s: torch.randn(*s, dtype=torch.bfloat16) * 0.05)(B, S, D)),
            "W_gate": _w((lambda *s: torch.randn(*s, dtype=torch.bfloat16) * 0.4)(D, F) * (2.0 / D) ** 0.5),
            "W_up": _w((lambda *s: torch.randn(*s, dtype=torch.bfloat16) * 0.4)(D, F) * (2.0 / D) ** 0.5),
            "W_down": _w((lambda *s: torch.randn(*s, dtype=torch.bfloat16) * 0.4)(F, D) * (1.0 / F) ** 0.5),
        }
    _B_in = _B_setup()

    return {
        "A_x": _A_in["x"],
        "A_c_kv": _A_in["c_kv"],
        "A_w_q": _A_in["w_q"],
        "A_w_uk": _A_in["w_uk"],
        "A_w_uv": _A_in["w_uv"],
        "A_w_o": _A_in["w_o"],
        "B_x": _B_in["x"],
        "B_W_gate": _B_in["W_gate"],
        "B_W_up": _B_in["W_up"],
        "B_W_down": _B_in["W_down"],
    }

def reference(A_x, A_c_kv, A_w_q, A_w_uk, A_w_uv, A_w_o, B_x, B_W_gate, B_W_up, B_W_down):
    def _A_ref(x, c_kv, w_q, w_uk, w_uv, w_o):
        B, Sq, M = x.shape[0], x.shape[1], x.shape[2]
        Sk = c_kv.shape[1]
        H, D = w_q.shape[1], w_q.shape[2]
        q = torch.einsum("bqm,mhd->bhqd", x, w_q)
        k = torch.einsum("bkc,chd->bhkd", c_kv, w_uk)
        v = torch.einsum("bkc,chd->bhkd", c_kv, w_uv)
        scores = torch.einsum("bhqd,bhkd->bhqk", q, k) * (D ** -0.5)
        off = Sk - Sq
        qi = torch.arange(Sq)[:, None]
        kj = torch.arange(Sk)[None, :]
        cmask = kj <= (qi + off)
        scores = torch.where(cmask[None, None], scores, -1e9)
        p = _softmax(scores, axis=-1)
        ctx = torch.einsum("bhqk,bhkd->bhqd", p, v)
        return torch.einsum("bhqd,hdm->bqm", ctx, w_o)

    def _B_ref(x, W_gate, W_up, W_down):
        gate = torch.einsum("bsd,df->bsf", x, W_gate)
        up = torch.einsum("bsd,df->bsf", x, W_up)
        gate = gate * (lambda x, dt: x.to(dt))(gate > 0, gate.dtype)
        h = gate * up
        return torch.einsum("bsf,fd->bsd", h, W_down)

    x = A_x
    h = x + _A_ref(_layernorm(x, axis=-1), A_c_kv, A_w_q, A_w_uk, A_w_uv, A_w_o)
    h2 = h + _B_ref(_layernorm(h, axis=-1), B_W_gate, B_W_up, B_W_down)
    return h2
```

```asm
; @launch grid=(256,1,1) block=(512,1,1) lds=133120
.amdgcn_target "amdgcn-amd-amdhsa--gfx950"
.text
.globl sequential_preLN__compressed_kv_cla__glu_gated_reglu__decode_kernel
.p2align 8
.type sequential_preLN__compressed_kv_cla__glu_gated_reglu__decode_kernel,@function
sequential_preLN__compressed_kv_cla__glu_gated_reglu__decode_kernel:
    s_cmp_ge_u32 s2, 256
    s_cbranch_scc1 L_end
    s_load_dwordx16 s[8:23], s[0:1], 0
    s_load_dwordx8 s[24:31], s[0:1], 64
    s_load_dwordx2 s[32:33], s[0:1], 96
    s_getpc_b64 s[42:43]
    v_lshlrev_b32 v1, 4, v0
    global_load_dwordx4 v[232:235], v1, s[42:43]
    v_lshrrev_b32 v1, 6, v0
    v_and_b32 v0, 63, v0
    v_readfirstlane_b32 s36, v1
    s_and_b32 s34, s2, 7
    s_lshr_b32 s35, s2, 3
    s_lshr_b32 s37, s35, 3
    s_lshl_b32 s48, s34, 2
    s_add_u32 s37, s37, s48
    s_and_b32 s38, s35, 7
    v_mov_b32 v1, 0
    v_lshlrev_b32 v3, 4, v0
    v_and_b32 v7, 15, v0
    v_lshrrev_b32 v6, 4, v0
    s_cmp_eq_u32 s36, 1
    s_cbranch_scc1 L_w1
    s_cmp_eq_u32 s36, 0
    s_cbranch_scc1 L_w0
    s_waitcnt lgkmcnt(0)
    s_cmp_ge_u32 s36, 4
    s_cbranch_scc0 L_e_nb
    s_cmp_ge_u32 s35, 16
    s_cbranch_scc1 L_e_b
    s_branch L_e_nb
L_e_b:
L_e_nb:
    s_waitcnt lgkmcnt(0)
    global_load_dword v2, v1, s[32:33] sc1
    s_cmp_eq_u32 s36, 3
    s_cbranch_scc0 L_nw7_1
    s_and_b32 s48, s35, 15
    s_lshl_b32 s48, s48, 10
    s_add_u32 s48, s48, 8192
    s_min_u32 s48, s48, L_codeend-sequential_preLN__compressed_kv_cla__glu_gated_reglu__decode_kernel-1088
    s_add_u32 s42, s42, s48
    s_addc_u32 s43, s43, 0
    global_load_dwordx4 v[236:239], v3, s[42:43]
L_nw7_1:
    s_cmp_ge_u32 s35, 16
    s_cbranch_scc0 L_pre
L_e_tag:
    s_cmp_eq_u32 s36, 2
    s_cbranch_scc0 L_b0
    s_waitcnt vmcnt(0)
    v_readfirstlane_b32 s39, v2
    s_nop 3
    s_mul_i32 s39, s39, 5
    s_add_u32 s39, s39, 0x9E3779B9
    s_getreg_b32 s48, hwreg(HW_REG_XCC_ID)
    s_and_b32 s48, s48, 0xf
    v_mov_b32 v12, s48
    v_mov_b32 v15, s39
    s_lshl_b32 s48, s34, 5
    s_add_u32 s48, s48, s35
    s_lshl_b32 s48, s48, 4
    s_add_u32 s48, s48, 4096
    v_mov_b32 v16, s48
    s_mov_b64 exec, 1
    global_store_dwordx4 v16, v[12:15], s[32:33] sc1
    s_mov_b64 exec, -1
    s_branch L_b0
L_w0:
    v_lshlrev_b32 v4, 2, v0
    v_min_u32 v5, 39, v0
    v_lshlrev_b32 v5, 2, v5
    s_mul_i32 s48, s38, 160
    v_add_u32 v5, s48, v5
    s_waitcnt lgkmcnt(0)
    global_load_dword v10, v4, s[8:9] offset:0
    global_load_dword v11, v4, s[8:9] offset:256
    global_load_dword v12, v4, s[8:9] offset:512
    global_load_dword v13, v4, s[8:9] offset:768
    global_load_dword v14, v4, s[8:9] offset:1024
    global_load_dword v15, v5, s[8:9]
    global_load_dword v2, v1, s[32:33] sc1
    s_mov_b32 s52, 0x3acccccd
    s_waitcnt vmcnt(2)
    v_lshlrev_b32 v16, 16, v10
    v_and_b32 v17, 0xffff0000, v10
    v_lshlrev_b32 v18, 16, v11
    v_and_b32 v19, 0xffff0000, v11
    v_lshlrev_b32 v20, 16, v12
    v_and_b32 v21, 0xffff0000, v12
    v_lshlrev_b32 v22, 16, v13
    v_and_b32 v23, 0xffff0000, v13
    v_lshlrev_b32 v24, 16, v14
    v_and_b32 v25, 0xffff0000, v14
    v_readfirstlane_b32 s53, v16
    s_nop 3
    v_subrev_f32 v16, s53, v16
    v_subrev_f32 v17, s53, v17
    v_subrev_f32 v18, s53, v18
    v_subrev_f32 v19, s53, v19
    v_subrev_f32 v20, s53, v20
    v_subrev_f32 v21, s53, v21
    v_subrev_f32 v22, s53, v22
    v_subrev_f32 v23, s53, v23
    v_subrev_f32 v24, s53, v24
    v_subrev_f32 v25, s53, v25
    v_pk_mul_f32 v[26:27], v[16:17], v[16:17]
    v_pk_add_f32 v[28:29], v[16:17], v[18:19]
    v_pk_fma_f32 v[26:27], v[18:19], v[18:19], v[26:27]
    v_pk_fma_f32 v[26:27], v[20:21], v[20:21], v[26:27]
    v_pk_add_f32 v[28:29], v[28:29], v[20:21]
    v_pk_fma_f32 v[26:27], v[22:23], v[22:23], v[26:27]
    v_pk_add_f32 v[28:29], v[28:29], v[22:23]
    v_pk_fma_f32 v[26:27], v[24:25], v[24:25], v[26:27]
    v_pk_add_f32 v[28:29], v[28:29], v[24:25]
    v_add_f32 v27, v26, v27
    v_add_f32 v26, v28, v29
    s_nop 1
    v_add_f32_dpp v26, v26, v26 quad_perm:[1,0,3,2] row_mask:0xf bank_mask:0xf
    v_add_f32_dpp v27, v27, v27 quad_perm:[1,0,3,2] row_mask:0xf bank_mask:0xf
    s_nop 0
    v_add_f32_dpp v26, v26, v26 quad_perm:[2,3,0,1] row_mask:0xf bank_mask:0xf
    v_add_f32_dpp v27, v27, v27 quad_perm:[2,3,0,1] row_mask:0xf bank_mask:0xf
    s_nop 0
    v_add_f32_dpp v26, v26, v26 row_half_mirror row_mask:0xf bank_mask:0xf
    v_add_f32_dpp v27, v27, v27 row_half_mirror row_mask:0xf bank_mask:0xf
    s_nop 0
    v_add_f32_dpp v26, v26, v26 row_mirror row_mask:0xf bank_mask:0xf
    v_add_f32_dpp v27, v27, v27 row_mirror row_mask:0xf bank_mask:0xf
    s_nop 0
    v_mov_b32 v28, v26
    v_mov_b32 v29, v27
    s_nop 0
    v_permlane16_swap_b32 v28, v26
    v_permlane16_swap_b32 v29, v27
    v_add_f32 v26, v26, v28
    v_add_f32 v27, v27, v29
    v_mov_b32 v28, v26
    v_mov_b32 v29, v27
    s_nop 0
    v_permlane32_swap_b32 v28, v26
    v_permlane32_swap_b32 v29, v27
    v_add_f32 v26, v26, v28
    v_add_f32 v27, v27, v29
    s_mov_b32 s52, 0x3acccccd
    v_mul_f32 v26, s52, v26
    v_mul_f32 v27, s52, v27
    v_fma_f32 v27, -v26, v26, v27
    v_max_f32 v27, 0, v27
    v_add_f32 v28, s53, v26
    v_cvt_pk_bf16_f32 v28, v28, v28
    v_and_b32 v28, 0xffff0000, v28
    v_cvt_pk_bf16_f32 v27, v27, v27
    v_and_b32 v27, 0xffff0000, v27
    v_add_f32 v27, 0x3727c5ac, v27
    v_cvt_pk_bf16_f32 v27, v27, v27
    v_and_b32 v27, 0xffff0000, v27
    v_sqrt_f32 v27, v27
    s_nop 0
    v_cvt_pk_bf16_f32 v27, v27, v27
    v_and_b32 v27, 0xffff0000, v27
    v_rcp_f32 v29, v27
    s_nop 0
    s_waitcnt vmcnt(1)
    v_lshlrev_b32 v16, 16, v15
    v_and_b32 v17, 0xffff0000, v15
    v_sub_f32 v16, v16, v28
    v_sub_f32 v17, v17, v28
    v_cvt_pk_bf16_f32 v18, v16, v17
    v_lshlrev_b32 v16, 16, v18
    v_and_b32 v17, 0xffff0000, v18
    v_mul_f32 v16, v16, v29
    v_mul_f32 v17, v17, v29
    v_cvt_pk_bf16_f32 v18, v16, v17
    ds_write_b32 v4, v18 offset:0
    s_waitcnt lgkmcnt(0)
    s_barrier
    s_waitcnt vmcnt(0)
    v_readfirstlane_b32 s39, v2
    s_nop 3
    s_mul_i32 s39, s39, 5
    s_add_u32 s39, s39, 0x9E3779B9
    s_cmp_ge_u32 s35, 16
    s_cbranch_scc1 L_pathB
    s_branch L_pre0
L_w1:
    s_mov_b32 s49, 163840
    v_mul_lo_u32 v8, v6, s49
    v_lshl_add_u32 v8, v7, 4, v8
    s_mul_i32 s48, s38, 655360
    s_lshl_b32 s49, s37, 8
    s_add_u32 s48, s48, s49
    s_waitcnt lgkmcnt(0)
    s_add_u32 s40, s12, s48
    s_addc_u32 s41, s13, 0
    global_load_dwordx4 v[80:83], v8, s[40:41]
    s_add_u32 s40, s40, 8192
    s_addc_u32 s41, s41, 0
    global_load_dwordx4 v[84:87], v8, s[40:41]
    s_add_u32 s40, s40, 8192
    s_addc_u32 s41, s41, 0
    global_load_dwordx4 v[88:91], v8, s[40:41]
    s_add_u32 s40, s40, 8192
    s_addc_u32 s41, s41, 0
    global_load_dwordx4 v[92:95], v8, s[40:41]
    s_add_u32 s40, s40, 8192
    s_addc_u32 s41, s41, 0
    global_load_dwordx4 v[96:99], v8, s[40:41]
    s_add_u32 s40, s40, 8192
    s_addc_u32 s41, s41, 0
    global_load_dwordx4 v[100:103], v8, s[40:41]
    s_add_u32 s40, s40, 8192
    s_addc_u32 s41, s41, 0
    global_load_dwordx4 v[104:107], v8, s[40:41]
    s_add_u32 s40, s40, 8192
    s_addc_u32 s41, s41, 0
    global_load_dwordx4 v[108:111], v8, s[40:41]
    s_add_u32 s40, s40, 8192
    s_addc_u32 s41, s41, 0
    global_load_dwordx4 v[112:115], v8, s[40:41]
    s_add_u32 s40, s40, 8192
    s_addc_u32 s41, s41, 0
    global_load_dwordx4 v[116:119], v8, s[40:41]
    s_add_u32 s40, s40, 8192
    s_addc_u32 s41, s41, 0
    global_load_dwordx4 v[120:123], v8, s[40:41]
    s_add_u32 s40, s40, 8192
    s_addc_u32 s41, s41, 0
    global_load_dwordx4 v[124:127], v8, s[40:41]
    s_add_u32 s40, s40, 8192
    s_addc_u32 s41, s41, 0
    global_load_dwordx4 v[128:131], v8, s[40:41]
    s_add_u32 s40, s40, 8192
    s_addc_u32 s41, s41, 0
    global_load_dwordx4 v[132:135], v8, s[40:41]
    s_add_u32 s40, s40, 8192
    s_addc_u32 s41, s41, 0
    global_load_dwordx4 v[136:139], v8, s[40:41]
    s_add_u32 s40, s40, 8192
    s_addc_u32 s41, s41, 0
    global_load_dwordx4 v[140:143], v8, s[40:41]
    s_add_u32 s40, s40, 8192
    s_addc_u32 s41, s41, 0
    global_load_dwordx4 v[144:147], v8, s[40:41]
    s_add_u32 s40, s40, 8192
    s_addc_u32 s41, s41, 0
    global_load_dwordx4 v[148:151], v8, s[40:41]
    s_add_u32 s40, s40, 8192
    s_addc_u32 s41, s41, 0
    global_load_dwordx4 v[152:155], v8, s[40:41]
    s_add_u32 s40, s40, 8192
    s_addc_u32 s41, s41, 0
    global_load_dwordx4 v[156:159], v8, s[40:41]
    global_load_dword v2, v1, s[32:33] sc1
    v_and_b32 v16, 7, v0
    v_and_b32 v17, 1, v0
    v_cmp_eq_u32 vcc, 1, v17
    v_mov_b32 v192, 0xc0c0100
    v_mov_b32 v194, 0x1000c0c
    v_cndmask_b32 v192, v192, v194, vcc
    v_cmp_eq_u32 vcc, 1, v17
    v_mov_b32 v193, 0xc0c0302
    v_mov_b32 v195, 0x3020c0c
    v_cndmask_b32 v193, v193, v195, vcc
    v_lshrrev_b32 v16, 1, v16
    v_mov_b32 v17, 0x0c0c0c0c
    v_cmp_eq_u32 vcc, 3, v16
    s_nop 0
    v_cndmask_b32 v198, v17, v192, vcc
    v_cndmask_b32 v199, v17, v193, vcc
    v_cmp_eq_u32 vcc, 2, v16
    s_nop 0
    v_cndmask_b32 v196, v17, v192, vcc
    v_cndmask_b32 v197, v17, v193, vcc
    v_cmp_eq_u32 vcc, 1, v16
    s_nop 0
    v_cndmask_b32 v194, v17, v192, vcc
    v_cndmask_b32 v195, v17, v193, vcc
    v_cmp_eq_u32 vcc, 0, v16
    s_nop 0
    v_cndmask_b32 v192, v17, v192, vcc
    v_cndmask_b32 v193, v17, v193, vcc
    s_lshl_b32 s48, s37, 3
    s_add_u32 s48, s48, s38
    s_lshl_b32 s48, s48, 10
    s_add_u32 s49, s48, 65536
    s_add_u32 s44, s32, s49
    s_addc_u32 s45, s33, 0
    s_add_u32 s49, s48, 327680
    s_add_u32 s46, s32, s49
    s_addc_u32 s47, s33, 0
    v_mul_u32_u24 v19, 40, v6
    s_mov_b32 s56, 0
    s_mov_b32 s57, -1
    s_barrier
    ds_read_b64 v[16:17], v19 offset:0
    ds_read_b64 v[18:19], v19 offset:8
    ds_read_b64 v[20:21], v19 offset:16
    ds_read_b64 v[22:23], v19 offset:24
    ds_read_b64 v[24:25], v19 offset:32
    s_waitcnt lgkmcnt(0)
    v_perm_b32 v160, v16, v16, v192
    v_perm_b32 v161, v16, v16, v194
    v_perm_b32 v162, v16, v16, v196
    v_perm_b32 v163, v16, v16, v198
    v_perm_b32 v164, v16, v16, v193
    v_perm_b32 v165, v16, v16, v195
    v_perm_b32 v166, v16, v16, v197
    v_perm_b32 v167, v16, v16, v199
    v_perm_b32 v168, v17, v17, v192
    v_perm_b32 v169, v17, v17, v194
    v_perm_b32 v170, v17, v17, v196
    v_perm_b32 v171, v17, v17, v198
    s_waitcnt vmcnt(20)
    v_mfma_f32_16x16x32_bf16 v[200:203], v[160:163], v[80:83], 0
    v_perm_b32 v172, v17, v17, v193
    v_perm_b32 v173, v17, v17, v195
    v_perm_b32 v174, v17, v17, v197
    v_perm_b32 v175, v17, v17, v199
    s_waitcnt vmcnt(19)
    v_mfma_f32_16x16x32_bf16 v[200:203], v[164:167], v[84:87], v[200:203]
    v_perm_b32 v160, v18, v18, v192
    v_perm_b32 v161, v18, v18, v194
    v_perm_b32 v162, v18, v18, v196
    v_perm_b32 v163, v18, v18, v198
    s_waitcnt vmcnt(18)
    v_mfma_f32_16x16x32_bf16 v[200:203], v[168:171], v[88:91], v[200:203]
    v_perm_b32 v164, v18, v18, v193
    v_perm_b32 v165, v18, v18, v195
    v_perm_b32 v166, v18, v18, v197
    v_perm_b32 v167, v18, v18, v199
    s_waitcnt vmcnt(17)
    v_mfma_f32_16x16x32_bf16 v[200:203], v[172:175], v[92:95], v[200:203]
    v_perm_b32 v168, v19, v19, v192
    v_perm_b32 v169, v19, v19, v194
    v_perm_b32 v170, v19, v19, v196
    v_perm_b32 v171, v19, v19, v198
    s_waitcnt vmcnt(16)
    v_mfma_f32_16x16x32_bf16 v[200:203], v[160:163], v[96:99], v[200:203]
    v_perm_b32 v172, v19, v19, v193
    v_perm_b32 v173, v19, v19, v195
    v_perm_b32 v174, v19, v19, v197
    v_perm_b32 v175, v19, v19, v199
    s_waitcnt vmcnt(15)
    v_mfma_f32_16x16x32_bf16 v[200:203], v[164:167], v[100:103], v[200:203]
    v_perm_b32 v160, v20, v20, v192
    v_perm_b32 v161, v20, v20, v194
    v_perm_b32 v162, v20, v20, v196
    v_perm_b32 v163, v20, v20, v198
    s_waitcnt vmcnt(14)
    v_mfma_f32_16x16x32_bf16 v[200:203], v[168:171], v[104:107], v[200:203]
    v_perm_b32 v164, v20, v20, v193
    v_perm_b32 v165, v20, v20, v195
    v_perm_b32 v166, v20, v20, v197
    v_perm_b32 v167, v20, v20, v199
    s_waitcnt vmcnt(13)
    v_mfma_f32_16x16x32_bf16 v[200:203], v[172:175], v[108:111], v[200:203]
    v_perm_b32 v168, v21, v21, v192
    v_perm_b32 v169, v21, v21, v194
    v_perm_b32 v170, v21, v21, v196
    v_perm_b32 v171, v21, v21, v198
    s_waitcnt vmcnt(12)
    v_mfma_f32_16x16x32_bf16 v[200:203], v[160:163], v[112:115], v[200:203]
    v_perm_b32 v172, v21, v21, v193
    v_perm_b32 v173, v21, v21, v195
    v_perm_b32 v174, v21, v21, v197
    v_perm_b32 v175, v21, v21, v199
    s_waitcnt vmcnt(11)
    v_mfma_f32_16x16x32_bf16 v[200:203], v[164:167], v[116:119], v[200:203]
    v_perm_b32 v160, v22, v22, v192
    v_perm_b32 v161, v22, v22, v194
    v_perm_b32 v162, v22, v22, v196
    v_perm_b32 v163, v22, v22, v198
    s_waitcnt vmcnt(10)
    v_mfma_f32_16x16x32_bf16 v[200:203], v[168:171], v[120:123], v[200:203]
    v_perm_b32 v164, v22, v22, v193
    v_perm_b32 v165, v22, v22, v195
    v_perm_b32 v166, v22, v22, v197
    v_perm_b32 v167, v22, v22, v199
    s_waitcnt vmcnt(9)
    v_mfma_f32_16x16x32_bf16 v[200:203], v[172:175], v[124:127], v[200:203]
    v_perm_b32 v168, v23, v23, v192
    v_perm_b32 v169, v23, v23, v194
    v_perm_b32 v170, v23, v23, v196
    v_perm_b32 v171, v23, v23, v198
    s_waitcnt vmcnt(8)
    v_mfma_f32_16x16x32_bf16 v[200:203], v[160:163], v[128:131], v[200:203]
    v_perm_b32 v172, v23, v23, v193
    v_perm_b32 v173, v23, v23, v195
    v_perm_b32 v174, v23, v23, v197
    v_perm_b32 v175, v23, v23, v199
    s_waitcnt vmcnt(7)
    v_mfma_f32_16x16x32_bf16 v[200:203], v[164:167], v[132:135], v[200:203]
    v_perm_b32 v160, v24, v24, v192
    v_perm_b32 v161, v24, v24, v194
    v_perm_b32 v162, v24, v24, v196
    v_perm_b32 v163, v24, v24, v198
    s_waitcnt vmcnt(6)
    v_mfma_f32_16x16x32_bf16 v[200:203], v[168:171], v[136:139], v[200:203]
    v_perm_b32 v164, v24, v24, v193
    v_perm_b32 v165, v24, v24, v195
    v_perm_b32 v166, v24, v24, v197
    v_perm_b32 v167, v24, v24, v199
    s_waitcnt vmcnt(5)
    v_mfma_f32_16x16x32_bf16 v[200:203], v[172:175], v[140:143], v[200:203]
    v_perm_b32 v168, v25, v25, v192
    v_perm_b32 v169, v25, v25, v194
    v_perm_b32 v170, v25, v25, v196
    v_perm_b32 v171, v25, v25, v198
    s_waitcnt vmcnt(4)
    v_mfma_f32_16x16x32_bf16 v[200:203], v[160:163], v[144:147], v[200:203]
    v_perm_b32 v172, v25, v25, v193
    v_perm_b32 v173, v25, v25, v195
    v_perm_b32 v174, v25, v25, v197
    v_perm_b32 v175, v25, v25, v199
    s_waitcnt vmcnt(3)
    v_mfma_f32_16x16x32_bf16 v[200:203], v[164:167], v[148:151], v[200:203]
    s_waitcnt vmcnt(2)
    v_mfma_f32_16x16x32_bf16 v[200:203], v[168:171], v[152:155], v[200:203]
    s_waitcnt vmcnt(1)
    v_mfma_f32_16x16x32_bf16 v[200:203], v[172:175], v[156:159], v[200:203]
    s_waitcnt vmcnt(0)
    v_readfirstlane_b32 s39, v2
    s_nop 3
    s_mul_i32 s39, s39, 5
    s_add_u32 s39, s39, 0x9E3779B9
    v_mov_b32 v207, s39
    v_cndmask_b32 v204, v200, v202, s[56:57]
    v_cndmask_b32 v205, v201, v203, s[56:57]
    global_store_dwordx4 v3, v[204:207], s[44:45]
    global_store_dwordx4 v3, v[204:207], s[46:47] sc1
    s_cmp_ge_u32 s35, 16
    s_cbranch_scc1 L_pathB
    s_branch L_bp1
L_b0:
    s_barrier
    s_waitcnt vmcnt(0)
    v_readfirstlane_b32 s39, v2
    s_nop 3
    s_mul_i32 s39, s39, 5
    s_add_u32 s39, s39, 0x9E3779B9
    s_cmp_ge_u32 s36, 4
    s_cbranch_scc0 L_pathB
    s_sub_u32 s54, s35, 16
    s_lshr_b32 s48, s54, 2
    s_lshl_b32 s49, s34, 2
    s_add_u32 s48, s48, s49
    s_lshl_b32 s48, s48, 8
    s_and_b32 s49, s54, 3
    s_lshl_b32 s49, s49, 2
    s_add_u32 s49, s49, s36
    s_sub_u32 s49, s49, 4
    s_lshl_b32 s49, s49, 18
    s_add_u32 s48, s48, s49
    s_add_u32 s40, s14, s48
    s_addc_u32 s41, s15, 0
    v_xor_b32 v8, v7, v6
    v_lshlrev_b32 v8, 4, v8
    v_lshl_add_u32 v8, v6, 13, v8
    v_xor_b32 v9, 64, v8
    v_xor_b32 v10, 128, v8
    v_xor_b32 v11, 192, v8
    s_and_b32 s49, s36, 3
    s_lshl_b32 s49, s49, 13
    s_add_u32 m0, s49, 59392
    s_nop 0
    global_load_lds_dwordx4 v8, s[40:41]
    s_add_u32 m0, m0, 1024
    s_add_u32 s40, s40, 32768
    s_addc_u32 s41, s41, 0
    global_load_lds_dwordx4 v9, s[40:41]
    s_add_u32 m0, m0, 1024
    s_add_u32 s40, s40, 32768
    s_addc_u32 s41, s41, 0
    global_load_lds_dwordx4 v10, s[40:41]
    s_add_u32 m0, m0, 1024
    s_add_u32 s40, s40, 32768
    s_addc_u32 s41, s41, 0
    global_load_lds_dwordx4 v11, s[40:41]
    s_add_u32 m0, m0, 1024
    s_add_u32 s40, s40, 32768
    s_addc_u32 s41, s41, 0
    global_load_lds_dwordx4 v8, s[40:41]
    s_add_u32 m0, m0, 1024
    s_add_u32 s40, s40, 32768
    s_addc_u32 s41, s41, 0
    global_load_lds_dwordx4 v9, s[40:41]
    s_add_u32 m0, m0, 1024
    s_add_u32 s40, s40, 32768
    s_addc_u32 s41, s41, 0
    global_load_lds_dwordx4 v10, s[40:41]
    s_add_u32 m0, m0, 1024
    s_add_u32 s40, s40, 32768
    s_addc_u32 s41, s41, 0
    global_load_lds_dwordx4 v11, s[40:41]
    s_waitcnt vmcnt(0)
    s_branch L_pathB
L_pre:
    s_and_b32 s55, s35, 1
    s_lshr_b32 s56, s35, 1
    v_and_b32 v8, 7, v0
    v_lshlrev_b32 v8, 1, v8
    s_lshl_b32 s48, s36, 14
    s_add_u32 s48, s48, 59392
    v_add_u32 v9, 0, v6
    v_xor_b32 v9, v9, v8
    v_lshlrev_b32 v9, 4, v9
    v_lshl_add_u32 v32, v7, 10, v9
    v_add_u32 v36, s48, v32
    v_add_u32 v9, 4, v6
    v_xor_b32 v9, v9, v8
    v_lshlrev_b32 v9, 4, v9
    v_lshl_add_u32 v33, v7, 10, v9
    v_add_u32 v37, s48, v33
    v_add_u32 v9, 8, v6
    v_xor_b32 v9, v9, v8
    v_lshlrev_b32 v9, 4, v9
    v_lshl_add_u32 v34, v7, 10, v9
    v_add_u32 v38, s48, v34
    v_add_u32 v9, 12, v6
    v_xor_b32 v9, v9, v8
    v_lshlrev_b32 v9, 4, v9
    v_lshl_add_u32 v35, v7, 10, v9
    v_add_u32 v39, s48, v35
    v_lshrrev_b32 v9, 2, v0
    v_lshlrev_b32 v9, 7, v9
    v_and_b32 v11, 3, v0
    v_lshl_add_u32 v9, v11, 3, v9
    v_bfe_u32 v10, v0, 3, 2
    s_and_b32 s48, s36, 3
    v_xor_b32 v10, s48, v10
    v_lshl_add_u32 v9, v10, 5, v9
    v_add_u32 v40, 26624, v9
    v_lshrrev_b32 v9, 3, v0
    v_lshlrev_b32 v9, 10, v9
    v_and_b32 v10, 7, v0
    v_lshlrev_b32 v11, 1, v6
    v_xor_b32 v10, v10, v11
    v_lshl_add_u32 v41, v10, 4, v9
    s_lshl_b32 s48, s34, 19
    s_and_b32 s49, s36, 3
    s_lshl_b32 s49, s49, 16
    s_add_u32 s48, s48, s49
    s_lshl_b32 s49, s56, 7
    s_add_u32 s48, s48, s49
    s_waitcnt lgkmcnt(0)
    s_add_u32 s98, s10, s48
    s_addc_u32 s99, s11, 0
    v_lshrrev_b32 v9, 1, v0
    v_and_b32 v10, 1, v0
    v_lshlrev_b32 v10, 3, v10
    s_lshl_b32 s48, s36, 1
    s_add_u32 s48, s48, 0
    s_and_b32 s49, s48, 7
    s_lshl_b32 s49, s49, 1
    v_xor_b32 v11, s49, v9
    v_lshl_add_u32 v11, v11, 4, v10
    s_lshl_b32 s48, s48, 10
    s_add_u32 s48, s48, 10240
    v_add_u32 v44, s48, v11
    s_lshl_b32 s48, s36, 1
    s_add_u32 s48, s48, 1
    s_and_b32 s49, s48, 7
    s_lshl_b32 s49, s49, 1
    v_xor_b32 v11, s49, v9
    v_lshl_add_u32 v11, v11, 4, v10
    s_lshl_b32 s48, s48, 10
    s_add_u32 s48, s48, 10240
    v_add_u32 v45, s48, v11
    v_and_b32 v9, 7, v0
    v_and_b32 v10, 1, v0
    v_cmp_eq_u32 vcc, 1, v10
    v_mov_b32 v240, 0xffff
    v_mov_b32 v241, 0xffff0000
    v_cndmask_b32 v10, v240, v241, vcc
    v_lshrrev_b32 v9, 1, v9
    v_cmp_eq_u32 vcc, 0, v9
    s_nop 0
    v_cndmask_b32 v240, 0, v10, vcc
    v_cmp_eq_u32 vcc, 1, v9
    s_nop 0
    v_cndmask_b32 v241, 0, v10, vcc
    v_cmp_eq_u32 vcc, 2, v9
    s_nop 0
    v_cndmask_b32 v242, 0, v10, vcc
    v_cmp_eq_u32 vcc, 3, v9
    s_nop 0
    v_cndmask_b32 v243, 0, v10, vcc
    v_lshlrev_b32 v46, 4, v7
    s_lshl_b32 s48, s36, 2
    v_add_u32 v47, s48, v46
    v_lshlrev_b32 v57, 3, v0
    v_add_u32 v42, 10240, v3
    s_lshl_b32 s48, s36, 11
    v_add_u32 v56, s48, v42
    v_lshlrev_b32 v43, 5, v7
    v_add_u32 v43, 3072, v43
    s_lshl_b32 s48, s36, 2
    v_add_u32 v59, s48, v43
    s_lshl_b32 s48, s55, 15
    s_lshl_b32 s49, s36, 12
    s_add_u32 s48, s48, s49
    s_add_u32 s48, s48, 589824
    v_add_u32 v248, s48, v3
    s_lshl_b32 s48, s34, 16
    s_lshl_b32 s49, s55, 15
    s_add_u32 s48, s48, s49
    s_add_u32 s48, s48, 2097152
    s_lshl_b32 s49, s36, 12
    s_add_u32 s49, s49, s48
    v_add_u32 v246, s49, v3
    s_lshl_b32 s49, s56, 12
    s_add_u32 s48, s48, s49
    v_add_u32 v251, s48, v3
    s_and_b32 s49, s36, 3
    s_lshl_b32 s49, s49, 10
    v_add_u32 v58, s49, v251
    s_lshl_b32 s48, s34, 16
    s_lshl_b32 s49, s55, 15
    s_add_u32 s48, s48, s49
    s_lshl_b32 s49, s56, 12
    s_add_u32 s48, s48, s49
    s_and_b32 s49, s36, 3
    s_lshl_b32 s49, s49, 10
    s_add_u32 s48, s48, s49
    s_add_u32 s48, s48, 1572864
    v_lshlrev_b32 v244, 6, v7
    v_lshl_add_u32 v244, v6, 4, v244
    v_add_u32 v244, s48, v244
    s_lshl_b32 s48, s34, 9
    s_lshl_b32 s49, s55, 8
    s_add_u32 s48, s48, s49
    s_add_u32 s48, s48, 819200
    v_add_u32 v250, s48, v3
    s_mov_b32 s58, s56
    s_lshr_b32 s48, s35, 2
    s_lshl_b32 s49, s34, 2
    s_add_u32 s61, s48, s49
    s_and_b32 s62, s35, 3
    v_bfe_u32 v13, v0, 2, 3
    s_lshr_b32 s48, s61, 4
    s_lshl_b32 s48, s48, 5
    s_lshl_b32 s49, s62, 3
    s_add_u32 s48, s48, s49
    s_add_u32 s48, s48, s36
    s_lshl_b32 s48, s48, 10
    s_and_b32 s49, s61, 15
    s_lshl_b32 s49, s49, 6
    s_add_u32 s48, s48, s49
    s_add_u32 s48, s48, 1572864
    v_lshlrev_b32 v14, 16, v13
    v_and_b32 v12, 3, v0
    v_lshl_add_u32 v14, v12, 4, v14
    v_add_u32 v245, s48, v14
    s_lshl_b32 s48, s61, 4
    s_add_u32 s48, s48, 819200
    v_lshlrev_b32 v14, 9, v13
    v_add_u32 v14, s48, v14
    v_cmp_le_u32 vcc, 32, v0
    s_nop 0
    v_cndmask_b32 v245, v245, v14, vcc
    v_lshlrev_b32 v247, 5, v7
    v_lshl_add_u32 v247, v6, 4, v247
    s_lshl_b32 s48, s36, 9
    v_add_u32 v247, s48, v247
    s_lshl_b32 s48, s34, 4
    s_add_u32 s48, s48, s35
    s_lshl_b32 s48, s48, 9
    s_add_u32 s48, s48, 688128
    v_lshrrev_b32 v253, 1, v0
    v_lshl_add_u32 v253, v253, 4, s48
    s_lshl_b32 s48, s61, 8
    s_lshl_b32 s49, s62, 3
    s_add_u32 s49, s49, s36
    s_lshl_b32 s49, s49, 17
    s_add_u32 s48, s48, s49
    s_waitcnt lgkmcnt(0)
    s_add_u32 s96, s16, s48
    s_addc_u32 s97, s17, 0
    v_lshlrev_b32 v254, 13, v6
    v_lshl_add_u32 v254, v7, 4, v254
    s_waitcnt vmcnt(0)
    v_readfirstlane_b32 s39, v2
    s_nop 3
    s_mul_i32 s39, s39, 5
    s_add_u32 s39, s39, 0x9E3779B9
    global_load_dword v233, v245, s[32:33] sc1
    s_cmp_eq_u32 s36, 5
    s_cbranch_scc0 pt_2
    global_load_dword v234, v251, s[32:33] offset:0 sc1
    global_load_dword v235, v251, s[32:33] offset:1024 sc1
    global_load_dword v236, v251, s[32:33] offset:2048 sc1
    global_load_dword v237, v251, s[32:33] offset:3072 sc1
pt_2:
    s_cmp_eq_u32 s36, 2
    s_cbranch_scc0 L_pre_nx
    s_getreg_b32 s48, hwreg(HW_REG_XCC_ID)
    s_and_b32 s48, s48, 0xf
    v_mov_b32 v12, s48
    v_mov_b32 v15, s39
    s_lshl_b32 s48, s34, 5
    s_add_u32 s48, s48, s35
    s_lshl_b32 s48, s48, 4
    s_add_u32 s48, s48, 4096
    v_mov_b32 v16, s48
    s_mov_b64 exec, 1
    global_store_dwordx4 v16, v[12:15], s[32:33] sc1
    s_mov_b64 exec, -1
L_pre_nx:
    s_barrier
L_bp:
    s_barrier
    s_lshr_b32 s56, s35, 1
    s_lshl_b32 s57, s34, 3
    s_add_u32 s57, s57, s56
    s_lshl_b32 s48, s57, 6
    s_lshl_b32 s49, s36, 3
    s_add_u32 s48, s48, s49
    s_lshl_b32 s48, s48, 10
    s_add_u32 s40, s10, s48
    s_addc_u32 s41, s11, 0
    s_lshl_b32 s49, s49, 10
    s_add_u32 s49, s49, 59392
    s_mov_b32 m0, s49
    v_xor_b32 v4, 0, v3
    global_load_lds_dwordx4 v4, s[40:41] offset:0
    v_xor_b32 v4, 32, v3
    global_load_lds_dwordx4 v4, s[40:41] offset:1024
    v_xor_b32 v4, 64, v3
    global_load_lds_dwordx4 v4, s[40:41] offset:2048
    v_xor_b32 v4, 96, v3
    global_load_lds_dwordx4 v4, s[40:41] offset:3072
    s_add_u32 s49, s49, 4096
    s_mov_b32 m0, s49
    s_add_u32 s40, s40, 4096
    s_addc_u32 s41, s41, 0
    v_xor_b32 v4, 128, v3
    global_load_lds_dwordx4 v4, s[40:41] offset:0
    v_xor_b32 v4, 160, v3
    global_load_lds_dwordx4 v4, s[40:41] offset:1024
    v_xor_b32 v4, 192, v3
    global_load_lds_dwordx4 v4, s[40:41] offset:2048
    v_xor_b32 v4, 224, v3
    global_load_lds_dwordx4 v4, s[40:41] offset:3072
    s_branch L_a_dmadone
L_pre0:
    s_and_b32 s55, s35, 1
    s_lshr_b32 s56, s35, 1
    v_and_b32 v8, 7, v0
    v_lshlrev_b32 v8, 1, v8
    s_lshl_b32 s48, s36, 14
    s_add_u32 s48, s48, 59392
    v_add_u32 v9, 0, v6
    v_xor_b32 v9, v9, v8
    v_lshlrev_b32 v9, 4, v9
    v_lshl_add_u32 v32, v7, 10, v9
    v_add_u32 v36, s48, v32
    v_add_u32 v9, 4, v6
    v_xor_b32 v9, v9, v8
    v_lshlrev_b32 v9, 4, v9
    v_lshl_add_u32 v33, v7, 10, v9
    v_add_u32 v37, s48, v33
    v_add_u32 v9, 8, v6
    v_xor_b32 v9, v9, v8
    v_lshlrev_b32 v9, 4, v9
    v_lshl_add_u32 v34, v7, 10, v9
    v_add_u32 v38, s48, v34
    v_add_u32 v9, 12, v6
    v_xor_b32 v9, v9, v8
    v_lshlrev_b32 v9, 4, v9
    v_lshl_add_u32 v35, v7, 10, v9
    v_add_u32 v39, s48, v35
    v_lshrrev_b32 v9, 2, v0
    v_lshlrev_b32 v9, 7, v9
    v_and_b32 v11, 3, v0
    v_lshl_add_u32 v9, v11, 3, v9
    v_bfe_u32 v10, v0, 3, 2
    s_and_b32 s48, s36, 3
    v_xor_b32 v10, s48, v10
    v_lshl_add_u32 v9, v10, 5, v9
    v_add_u32 v40, 26624, v9
    v_lshrrev_b32 v9, 3, v0
    v_lshlrev_b32 v9, 10, v9
    v_and_b32 v10, 7, v0
    v_lshlrev_b32 v11, 1, v6
    v_xor_b32 v10, v10, v11
    v_lshl_add_u32 v41, v10, 4, v9
    s_lshl_b32 s48, s34, 19
    s_and_b32 s49, s36, 3
    s_lshl_b32 s49, s49, 16
    s_add_u32 s48, s48, s49
    s_lshl_b32 s49, s56, 7
    s_add_u32 s48, s48, s49
    s_waitcnt lgkmcnt(0)
    s_add_u32 s98, s10, s48
    s_addc_u32 s99, s11, 0
    v_lshrrev_b32 v9, 1, v0
    v_and_b32 v10, 1, v0
    v_lshlrev_b32 v10, 3, v10
    s_lshl_b32 s48, s36, 1
    s_add_u32 s48, s48, 0
    s_and_b32 s49, s48, 7
    s_lshl_b32 s49, s49, 1
    v_xor_b32 v11, s49, v9
    v_lshl_add_u32 v11, v11, 4, v10
    s_lshl_b32 s48, s48, 10
    s_add_u32 s48, s48, 10240
    v_add_u32 v44, s48, v11
    s_lshl_b32 s48, s36, 1
    s_add_u32 s48, s48, 1
    s_and_b32 s49, s48, 7
    s_lshl_b32 s49, s49, 1
    v_xor_b32 v11, s49, v9
    v_lshl_add_u32 v11, v11, 4, v10
    s_lshl_b32 s48, s48, 10
    s_add_u32 s48, s48, 10240
    v_add_u32 v45, s48, v11
    v_and_b32 v9, 7, v0
    v_and_b32 v10, 1, v0
    v_cmp_eq_u32 vcc, 1, v10
    v_mov_b32 v240, 0xffff
    v_mov_b32 v241, 0xffff0000
    v_cndmask_b32 v10, v240, v241, vcc
    v_lshrrev_b32 v9, 1, v9
    v_cmp_eq_u32 vcc, 0, v9
    s_nop 0
    v_cndmask_b32 v240, 0, v10, vcc
    v_cmp_eq_u32 vcc, 1, v9
    s_nop 0
    v_cndmask_b32 v241, 0, v10, vcc
    v_cmp_eq_u32 vcc, 2, v9
    s_nop 0
    v_cndmask_b32 v242, 0, v10, vcc
    v_cmp_eq_u32 vcc, 3, v9
    s_nop 0
    v_cndmask_b32 v243, 0, v10, vcc
    v_lshlrev_b32 v46, 4, v7
    s_lshl_b32 s48, s36, 2
    v_add_u32 v47, s48, v46
    v_lshlrev_b32 v57, 3, v0
    v_add_u32 v42, 10240, v3
    s_lshl_b32 s48, s36, 11
    v_add_u32 v56, s48, v42
    v_lshlrev_b32 v43, 5, v7
    v_add_u32 v43, 3072, v43
    s_lshl_b32 s48, s36, 2
    v_add_u32 v59, s48, v43
    s_lshl_b32 s48, s55, 15
    s_lshl_b32 s49, s36, 12
    s_add_u32 s48, s48, s49
    s_add_u32 s48, s48, 589824
    v_add_u32 v248, s48, v3
    s_lshl_b32 s48, s34, 16
    s_lshl_b32 s49, s55, 15
    s_add_u32 s48, s48, s49
    s_add_u32 s48, s48, 2097152
    s_lshl_b32 s49, s36, 12
    s_add_u32 s49, s49, s48
    v_add_u32 v246, s49, v3
    s_lshl_b32 s49, s56, 12
    s_add_u32 s48, s48, s49
    v_add_u32 v251, s48, v3
    s_and_b32 s49, s36, 3
    s_lshl_b32 s49, s49, 10
    v_add_u32 v58, s49, v251
    s_lshl_b32 s48, s34, 16
    s_lshl_b32 s49, s55, 15
    s_add_u32 s48, s48, s49
    s_lshl_b32 s49, s56, 12
    s_add_u32 s48, s48, s49
    s_and_b32 s49, s36, 3
    s_lshl_b32 s49, s49, 10
    s_add_u32 s48, s48, s49
    s_add_u32 s48, s48, 1572864
    v_lshlrev_b32 v244, 6, v7
    v_lshl_add_u32 v244, v6, 4, v244
    v_add_u32 v244, s48, v244
    s_lshl_b32 s48, s34, 9
    s_lshl_b32 s49, s55, 8
    s_add_u32 s48, s48, s49
    s_add_u32 s48, s48, 819200
    v_add_u32 v250, s48, v3
    s_mov_b32 s58, s56
    s_lshr_b32 s48, s35, 2
    s_lshl_b32 s49, s34, 2
    s_add_u32 s61, s48, s49
    s_and_b32 s62, s35, 3
    v_bfe_u32 v13, v0, 2, 3
    s_lshr_b32 s48, s61, 4
    s_lshl_b32 s48, s48, 5
    s_lshl_b32 s49, s62, 3
    s_add_u32 s48, s48, s49
    s_add_u32 s48, s48, s36
    s_lshl_b32 s48, s48, 10
    s_and_b32 s49, s61, 15
    s_lshl_b32 s49, s49, 6
    s_add_u32 s48, s48, s49
    s_add_u32 s48, s48, 1572864
    v_lshlrev_b32 v14, 16, v13
    v_and_b32 v12, 3, v0
    v_lshl_add_u32 v14, v12, 4, v14
    v_add_u32 v245, s48, v14
    s_lshl_b32 s48, s61, 4
    s_add_u32 s48, s48, 819200
    v_lshlrev_b32 v14, 9, v13
    v_add_u32 v14, s48, v14
    v_cmp_le_u32 vcc, 32, v0
    s_nop 0
    v_cndmask_b32 v245, v245, v14, vcc
    v_lshlrev_b32 v247, 5, v7
    v_lshl_add_u32 v247, v6, 4, v247
    s_lshl_b32 s48, s36, 9
    v_add_u32 v247, s48, v247
    s_lshl_b32 s48, s34, 4
    s_add_u32 s48, s48, s35
    s_lshl_b32 s48, s48, 9
    s_add_u32 s48, s48, 688128
    v_lshrrev_b32 v253, 1, v0
    v_lshl_add_u32 v253, v253, 4, s48
    s_lshl_b32 s48, s61, 8
    s_lshl_b32 s49, s62, 3
    s_add_u32 s49, s49, s36
    s_lshl_b32 s49, s49, 17
    s_add_u32 s48, s48, s49
    s_waitcnt lgkmcnt(0)
    s_add_u32 s96, s16, s48
    s_addc_u32 s97, s17, 0
    v_lshlrev_b32 v254, 13, v6
    v_lshl_add_u32 v254, v7, 4, v254
    global_load_dword v233, v245, s[32:33] sc1
    s_cmp_eq_u32 s36, 5
    s_cbranch_scc0 pt_3
    global_load_dword v234, v251, s[32:33] offset:0 sc1
    global_load_dword v235, v251, s[32:33] offset:1024 sc1
    global_load_dword v236, v251, s[32:33] offset:2048 sc1
    global_load_dword v237, v251, s[32:33] offset:3072 sc1
pt_3:
    s_branch L_bp
L_bp1:
    s_barrier
    s_lshr_b32 s56, s35, 1
    s_lshl_b32 s57, s34, 3
    s_add_u32 s57, s57, s56
    s_lshl_b32 s48, s57, 6
    s_lshl_b32 s49, s36, 3
    s_add_u32 s48, s48, s49
    s_lshl_b32 s48, s48, 10
    s_add_u32 s40, s10, s48
    s_addc_u32 s41, s11, 0
    s_lshl_b32 s49, s49, 10
    s_add_u32 s49, s49, 59392
    s_mov_b32 m0, s49
    v_xor_b32 v4, 0, v3
    global_load_lds_dwordx4 v4, s[40:41] offset:0
    v_xor_b32 v4, 32, v3
    global_load_lds_dwordx4 v4, s[40:41] offset:1024
    v_xor_b32 v4, 64, v3
    global_load_lds_dwordx4 v4, s[40:41] offset:2048
    v_xor_b32 v4, 96, v3
    global_load_lds_dwordx4 v4, s[40:41] offset:3072
    s_add_u32 s49, s49, 4096
    s_mov_b32 m0, s49
    s_add_u32 s40, s40, 4096
    s_addc_u32 s41, s41, 0
    v_xor_b32 v4, 128, v3
    global_load_lds_dwordx4 v4, s[40:41] offset:0
    v_xor_b32 v4, 160, v3
    global_load_lds_dwordx4 v4, s[40:41] offset:1024
    v_xor_b32 v4, 192, v3
    global_load_lds_dwordx4 v4, s[40:41] offset:2048
    v_xor_b32 v4, 224, v3
    global_load_lds_dwordx4 v4, s[40:41] offset:3072
    s_and_b32 s55, s35, 1
    s_lshr_b32 s56, s35, 1
    v_and_b32 v8, 7, v0
    v_lshlrev_b32 v8, 1, v8
    s_lshl_b32 s48, s36, 14
    s_add_u32 s48, s48, 59392
    v_add_u32 v9, 0, v6
    v_xor_b32 v9, v9, v8
    v_lshlrev_b32 v9, 4, v9
    v_lshl_add_u32 v32, v7, 10, v9
    v_add_u32 v36, s48, v32
    v_add_u32 v9, 4, v6
    v_xor_b32 v9, v9, v8
    v_lshlrev_b32 v9, 4, v9
    v_lshl_add_u32 v33, v7, 10, v9
    v_add_u32 v37, s48, v33
    v_add_u32 v9, 8, v6
    v_xor_b32 v9, v9, v8
    v_lshlrev_b32 v9, 4, v9
    v_lshl_add_u32 v34, v7, 10, v9
    v_add_u32 v38, s48, v34
    v_add_u32 v9, 12, v6
    v_xor_b32 v9, v9, v8
    v_lshlrev_b32 v9, 4, v9
    v_lshl_add_u32 v35, v7, 10, v9
    v_add_u32 v39, s48, v35
    v_lshrrev_b32 v9, 2, v0
    v_lshlrev_b32 v9, 7, v9
    v_and_b32 v11, 3, v0
    v_lshl_add_u32 v9, v11, 3, v9
    v_bfe_u32 v10, v0, 3, 2
    s_and_b32 s48, s36, 3
    v_xor_b32 v10, s48, v10
    v_lshl_add_u32 v9, v10, 5, v9
    v_add_u32 v40, 26624, v9
    v_lshrrev_b32 v9, 3, v0
    v_lshlrev_b32 v9, 10, v9
    v_and_b32 v10, 7, v0
    v_lshlrev_b32 v11, 1, v6
    v_xor_b32 v10, v10, v11
    v_lshl_add_u32 v41, v10, 4, v9
    s_lshl_b32 s48, s34, 19
    s_and_b32 s49, s36, 3
    s_lshl_b32 s49, s49, 16
    s_add_u32 s48, s48, s49
    s_lshl_b32 s49, s56, 7
    s_add_u32 s48, s48, s49
    s_waitcnt lgkmcnt(0)
    s_add_u32 s98, s10, s48
    s_addc_u32 s99, s11, 0
    v_lshrrev_b32 v9, 1, v0
    v_and_b32 v10, 1, v0
    v_lshlrev_b32 v10, 3, v10
    s_lshl_b32 s48, s36, 1
    s_add_u32 s48, s48, 0
    s_and_b32 s49, s48, 7
    s_lshl_b32 s49, s49, 1
    v_xor_b32 v11, s49, v9
    v_lshl_add_u32 v11, v11, 4, v10
    s_lshl_b32 s48, s48, 10
    s_add_u32 s48, s48, 10240
    v_add_u32 v44, s48, v11
    s_lshl_b32 s48, s36, 1
    s_add_u32 s48, s48, 1
    s_and_b32 s49, s48, 7
    s_lshl_b32 s49, s49, 1
    v_xor_b32 v11, s49, v9
    v_lshl_add_u32 v11, v11, 4, v10
    s_lshl_b32 s48, s48, 10
    s_add_u32 s48, s48, 10240
    v_add_u32 v45, s48, v11
    v_and_b32 v9, 7, v0
    v_and_b32 v10, 1, v0
    v_cmp_eq_u32 vcc, 1, v10
    v_mov_b32 v240, 0xffff
    v_mov_b32 v241, 0xffff0000
    v_cndmask_b32 v10, v240, v241, vcc
    v_lshrrev_b32 v9, 1, v9
    v_cmp_eq_u32 vcc, 0, v9
    s_nop 0
    v_cndmask_b32 v240, 0, v10, vcc
    v_cmp_eq_u32 vcc, 1, v9
    s_nop 0
    v_cndmask_b32 v241, 0, v10, vcc
    v_cmp_eq_u32 vcc, 2, v9
    s_nop 0
    v_cndmask_b32 v242, 0, v10, vcc
    v_cmp_eq_u32 vcc, 3, v9
    s_nop 0
    v_cndmask_b32 v243, 0, v10, vcc
    v_lshlrev_b32 v46, 4, v7
    s_lshl_b32 s48, s36, 2
    v_add_u32 v47, s48, v46
    v_lshlrev_b32 v57, 3, v0
    v_add_u32 v42, 10240, v3
    s_lshl_b32 s48, s36, 11
    v_add_u32 v56, s48, v42
    v_lshlrev_b32 v43, 5, v7
    v_add_u32 v43, 3072, v43
    s_lshl_b32 s48, s36, 2
    v_add_u32 v59, s48, v43
    s_lshl_b32 s48, s55, 15
    s_lshl_b32 s49, s36, 12
    s_add_u32 s48, s48, s49
    s_add_u32 s48, s48, 589824
    v_add_u32 v248, s48, v3
    s_lshl_b32 s48, s34, 16
    s_lshl_b32 s49, s55, 15
    s_add_u32 s48, s48, s49
    s_add_u32 s48, s48, 2097152
    s_lshl_b32 s49, s36, 12
    s_add_u32 s49, s49, s48
    v_add_u32 v246, s49, v3
    s_lshl_b32 s49, s56, 12
    s_add_u32 s48, s48, s49
    v_add_u32 v251, s48, v3
    s_and_b32 s49, s36, 3
    s_lshl_b32 s49, s49, 10
    v_add_u32 v58, s49, v251
    s_lshl_b32 s48, s34, 16
    s_lshl_b32 s49, s55, 15
    s_add_u32 s48, s48, s49
    s_lshl_b32 s49, s56, 12
    s_add_u32 s48, s48, s49
    s_and_b32 s49, s36, 3
    s_lshl_b32 s49, s49, 10
    s_add_u32 s48, s48, s49
    s_add_u32 s48, s48, 1572864
    v_lshlrev_b32 v244, 6, v7
    v_lshl_add_u32 v244, v6, 4, v244
    v_add_u32 v244, s48, v244
    s_lshl_b32 s48, s34, 9
    s_lshl_b32 s49, s55, 8
    s_add_u32 s48, s48, s49
    s_add_u32 s48, s48, 819200
    v_add_u32 v250, s48, v3
    s_mov_b32 s58, s56
    s_lshr_b32 s48, s35, 2
    s_lshl_b32 s49, s34, 2
    s_add_u32 s61, s48, s49
    s_and_b32 s62, s35, 3
    v_bfe_u32 v13, v0, 2, 3
    s_lshr_b32 s48, s61, 4
    s_lshl_b32 s48, s48, 5
    s_lshl_b32 s49, s62, 3
    s_add_u32 s48, s48, s49
    s_add_u32 s48, s48, s36
    s_lshl_b32 s48, s48, 10
    s_and_b32 s49, s61, 15
    s_lshl_b32 s49, s49, 6
    s_add_u32 s48, s48, s49
    s_add_u32 s48, s48, 1572864
    v_lshlrev_b32 v14, 16, v13
    v_and_b32 v12, 3, v0
    v_lshl_add_u32 v14, v12, 4, v14
    v_add_u32 v245, s48, v14
    s_lshl_b32 s48, s61, 4
    s_add_u32 s48, s48, 819200
    v_lshlrev_b32 v14, 9, v13
    v_add_u32 v14, s48, v14
    v_cmp_le_u32 vcc, 32, v0
    s_nop 0
    v_cndmask_b32 v245, v245, v14, vcc
    v_lshlrev_b32 v247, 5, v7
    v_lshl_add_u32 v247, v6, 4, v247
    s_lshl_b32 s48, s36, 9
    v_add_u32 v247, s48, v247
    s_lshl_b32 s48, s34, 4
    s_add_u32 s48, s48, s35
    s_lshl_b32 s48, s48, 9
    s_add_u32 s48, s48, 688128
    v_lshrrev_b32 v253, 1, v0
    v_lshl_add_u32 v253, v253, 4, s48
    s_lshl_b32 s48, s61, 8
    s_lshl_b32 s49, s62, 3
    s_add_u32 s49, s49, s36
    s_lshl_b32 s49, s49, 17
    s_add_u32 s48, s48, s49
    s_waitcnt lgkmcnt(0)
    s_add_u32 s96, s16, s48
    s_addc_u32 s97, s17, 0
    v_lshlrev_b32 v254, 13, v6
    v_lshl_add_u32 v254, v7, 4, v254
    global_load_dword v233, v245, s[32:33] sc1
    s_cmp_eq_u32 s36, 5
    s_cbranch_scc0 pt_4
    global_load_dword v234, v251, s[32:33] offset:0 sc1
    global_load_dword v235, v251, s[32:33] offset:1024 sc1
    global_load_dword v236, v251, s[32:33] offset:2048 sc1
    global_load_dword v237, v251, s[32:33] offset:3072 sc1
pt_4:
L_a_dmadone:
    s_cmp_eq_u32 s36, 3
    s_cbranch_scc0 L_a_nochk
    s_lshl_b32 s48, s34, 9
    s_add_u32 s48, s48, 4096
    v_and_b32 v9, 31, v0
    v_lshlrev_b32 v9, 4, v9
    v_add_u32 v9, s48, v9
    s_getreg_b32 s52, hwreg(HW_REG_XCC_ID)
    s_and_b32 s52, s52, 0xf
    s_mov_b32 s50, 0
    s_mov_b32 s59, 0
L_a_chk:
    global_load_dwordx4 v[12:15], v9, s[32:33] sc1
    s_add_u32 s50, s50, 1
    s_waitcnt vmcnt(0)
    v_cmp_eq_u32 vcc, s39, v15
    s_cmp_eq_u64 vcc, exec
    s_cbranch_scc1 L_a_chk_ok
    s_cmp_lt_u32 s50, 64
    s_cbranch_scc1 L_a_chk
    s_branch L_a_chk_done
L_a_chk_ok:
    v_cmp_eq_u32 vcc, s52, v12
    s_cmp_eq_u64 vcc, exec
    s_cselect_b32 s59, 1, 0
L_a_chk_done:
    v_mov_b32 v12, s59
    ds_write_b32 v1, v12 offset:9728
L_a_nochk:
    s_waitcnt vmcnt(0) lgkmcnt(0)
    s_barrier
    s_cmp_lt_u32 s36, 4
    s_cbranch_scc0 skipfa_5
    ds_read_b128 v[96:99], v36 offset:0
    ds_read_b128 v[100:103], v37 offset:0
    ds_read_b128 v[104:107], v38 offset:0
    ds_read_b128 v[108:111], v39 offset:0
    ds_read_b128 v[112:115], v36 offset:256
    ds_read_b128 v[116:119], v37 offset:256
    ds_read_b128 v[120:123], v38 offset:256
    ds_read_b128 v[124:127], v39 offset:256
    ds_read_b128 v[128:131], v36 offset:512
    ds_read_b128 v[132:135], v37 offset:512
    ds_read_b128 v[136:139], v38 offset:512
    ds_read_b128 v[140:143], v39 offset:512
    ds_read_b128 v[144:147], v36 offset:768
    ds_read_b128 v[148:151], v37 offset:768
    ds_read_b128 v[152:155], v38 offset:768
    ds_read_b128 v[156:159], v39 offset:768
skipfa_5:
    s_cmp_ge_u32 s36, 4
    s_cbranch_scc0 L_a_nv1
    s_and_b32 s49, s36, 3
    s_lshl_b32 s49, s49, 13
    s_add_u32 m0, s49, 26624
    s_nop 0
    global_load_lds_dwordx4 v41, s[98:99]
    s_add_u32 m0, m0, 1024
    s_add_u32 s98, s98, 8192
    s_addc_u32 s99, s99, 0
    global_load_lds_dwordx4 v41, s[98:99]
    s_add_u32 m0, m0, 1024
    s_add_u32 s98, s98, 8192
    s_addc_u32 s99, s99, 0
    global_load_lds_dwordx4 v41, s[98:99]
    s_add_u32 m0, m0, 1024
    s_add_u32 s98, s98, 8192
    s_addc_u32 s99, s99, 0
    global_load_lds_dwordx4 v41, s[98:99]
    s_add_u32 m0, m0, 1024
    s_add_u32 s98, s98, 8192
    s_addc_u32 s99, s99, 0
    global_load_lds_dwordx4 v41, s[98:99]
    s_add_u32 m0, m0, 1024
    s_add_u32 s98, s98, 8192
    s_addc_u32 s99, s99, 0
    global_load_lds_dwordx4 v41, s[98:99]
    s_add_u32 m0, m0, 1024
    s_add_u32 s98, s98, 8192
    s_addc_u32 s99, s99, 0
    global_load_lds_dwordx4 v41, s[98:99]
    s_add_u32 m0, m0, 1024
    s_add_u32 s98, s98, 8192
    s_addc_u32 s99, s99, 0
    global_load_lds_dwordx4 v41, s[98:99]
    s_add_u32 s98, s98, 204800
    s_addc_u32 s99, s99, 0
L_a_nv1:
    ds_read_b32 v12, v1 offset:9728
    s_mov_b32 s63, 0x3e0293ee
    s_mov_b32 s50, 0
    global_load_dwordx4 v[16:19], v248, s[32:33] offset:0 sc1
    global_load_dwordx4 v[20:23], v248, s[32:33] offset:1024 sc1
    global_load_dwordx4 v[24:27], v248, s[32:33] offset:2048 sc1
    global_load_dwordx4 v[28:31], v248, s[32:33] offset:3072 sc1
qa_top_6:
    s_waitcnt vmcnt(0)
    v_cmp_ne_u32 s[10:11], s39, v19
    v_cmp_ne_u32 s[12:13], s39, v23
    v_cmp_ne_u32 s[14:15], s39, v27
    v_cmp_ne_u32 s[18:19], s39, v31
    s_or_b64 s[46:47], s[10:11], s[12:13]
    s_or_b64 s[46:47], s[46:47], s[14:15]
    s_or_b64 s[46:47], s[46:47], s[18:19]
    s_cbranch_scc1 qa_retry_8
qa_done_7:
    ds_write_b64 v44, v[16:17] offset:0
    ds_write_b64 v44, v[20:21] offset:512
    ds_write_b64 v45, v[24:25] offset:0
    ds_write_b64 v45, v[28:29] offset:512
    s_waitcnt lgkmcnt(0)
    v_readfirstlane_b32 s59, v12
    s_barrier
    s_cmp_ge_u32 s36, 4
    s_cbranch_scc1 L_a_v
    ds_read_b128 v[192:195], v32 offset:10240
    ds_read_b128 v[196:199], v33 offset:10240
    ds_read_b128 v[200:203], v34 offset:10240
    ds_read_b128 v[204:207], v35 offset:10240
    ds_read_b128 v[208:211], v32 offset:10496
    ds_read_b128 v[212:215], v33 offset:10496
    ds_read_b128 v[216:219], v34 offset:10496
    ds_read_b128 v[220:223], v35 offset:10496
    ds_read_b128 v[16:19], v32 offset:10752
    ds_read_b128 v[20:23], v33 offset:10752
    ds_read_b128 v[24:27], v34 offset:10752
    ds_read_b128 v[28:31], v35 offset:10752
    ds_read_b128 v[80:83], v32 offset:11008
    ds_read_b128 v[84:87], v33 offset:11008
    ds_read_b128 v[88:91], v34 offset:11008
    ds_read_b128 v[92:95], v35 offset:11008
    v_mov_b32 v63, s39
    s_waitcnt lgkmcnt(15)
    v_mfma_f32_16x16x32_bf16 v[48:51], v[96:99], v[192:195], 0
    s_waitcnt lgkmcnt(14)
    v_mfma_f32_16x16x32_bf16 v[48:51], v[100:103], v[196:199], v[48:51]
    s_waitcnt lgkmcnt(13)
    v_mfma_f32_16x16x32_bf16 v[48:51], v[104:107], v[200:203], v[48:51]
    s_waitcnt lgkmcnt(12)
    v_mfma_f32_16x16x32_bf16 v[48:51], v[108:111], v[204:207], v[48:51]
    s_waitcnt lgkmcnt(11)
    v_mfma_f32_16x16x32_bf16 v[48:51], v[112:115], v[208:211], v[48:51]
    s_waitcnt lgkmcnt(10)
    v_mfma_f32_16x16x32_bf16 v[48:51], v[116:119], v[212:215], v[48:51]
    s_waitcnt lgkmcnt(9)
    v_mfma_f32_16x16x32_bf16 v[48:51], v[120:123], v[216:219], v[48:51]
    s_waitcnt lgkmcnt(8)
    v_mfma_f32_16x16x32_bf16 v[48:51], v[124:127], v[220:223], v[48:51]
    s_waitcnt lgkmcnt(7)
    v_mfma_f32_16x16x32_bf16 v[48:51], v[128:131], v[16:19], v[48:51]
    s_waitcnt lgkmcnt(6)
    v_mfma_f32_16x16x32_bf16 v[48:51], v[132:135], v[20:23], v[48:51]
    s_waitcnt lgkmcnt(5)
    v_mfma_f32_16x16x32_bf16 v[48:51], v[136:139], v[24:27], v[48:51]
    s_waitcnt lgkmcnt(4)
    v_mfma_f32_16x16x32_bf16 v[48:51], v[140:143], v[28:31], v[48:51]
    s_waitcnt lgkmcnt(3)
    v_mfma_f32_16x16x32_bf16 v[48:51], v[144:147], v[80:83], v[48:51]
    s_waitcnt lgkmcnt(2)
    v_mfma_f32_16x16x32_bf16 v[48:51], v[148:151], v[84:87], v[48:51]
    s_waitcnt lgkmcnt(1)
    v_mfma_f32_16x16x32_bf16 v[48:51], v[152:155], v[88:91], v[48:51]
    s_waitcnt lgkmcnt(0)
    v_mfma_f32_16x16x32_bf16 v[48:51], v[156:159], v[92:95], v[48:51]
    s_nop 7
    v_max_f32 v52, v48, v49
    v_max3_f32 v52, v52, v50, v51
    v_mov_b32 v53, v52
    s_nop 1
    v_permlane16_swap_b32 v53, v52
    s_nop 0
    v_max_f32 v52, v52, v53
    v_mov_b32 v53, v52
    s_nop 1
    v_permlane32_swap_b32 v53, v52
    s_nop 0
    v_max_f32 v52, v52, v53
    ds_write_b32 v47, v52 offset:512
    s_waitcnt lgkmcnt(0)
    s_barrier
    ds_read_b128 v[52:55], v46 offset:512
    s_waitcnt lgkmcnt(0)
    v_max_f32 v52, v52, v53
    v_max3_f32 v52, v52, v54, v55
    v_mul_f32 v62, s63, v52
    v_fma_f32 v48, v48, s63, -v62
    v_fma_f32 v49, v49, s63, -v62
    v_fma_f32 v50, v50, s63, -v62
    v_fma_f32 v51, v51, s63, -v62
    v_exp_f32 v48, v48
    v_exp_f32 v49, v49
    v_exp_f32 v50, v50
    v_exp_f32 v51, v51
    s_nop 0
    v_cvt_pk_bf16_f32 v60, v48, v49
    v_cvt_pk_bf16_f32 v61, v50, v51
    s_cmp_eq_u32 s59, 1
    s_cbranch_scc0 ms_slow_13
    global_store_dwordx4 v58, v[60:63], s[32:33]
ms_done_14:
    s_barrier
L_a_px:
    s_mov_b32 s50, 0
    global_load_dwordx4 v[16:19], v246, s[32:33] offset:0 sc1
    global_load_dwordx4 v[20:23], v246, s[32:33] offset:1024 sc1
    global_load_dwordx4 v[24:27], v246, s[32:33] offset:2048 sc1
    global_load_dwordx4 v[28:31], v246, s[32:33] offset:3072 sc1
px_top_15:
    s_waitcnt vmcnt(0)
    v_cmp_ne_u32 s[10:11], s39, v19
    v_cmp_ne_u32 s[12:13], s39, v23
    v_cmp_ne_u32 s[14:15], s39, v27
    v_cmp_ne_u32 s[18:19], s39, v31
    s_or_b64 s[46:47], s[10:11], s[12:13]
    s_or_b64 s[46:47], s[46:47], s[14:15]
    s_or_b64 s[46:47], s[46:47], s[18:19]
    s_cbranch_scc1 px_retry_17
px_done_16:
    ds_write_b64 v56, v[16:17] offset:0
    ds_write_b64 v56, v[20:21] offset:8
    ds_write_b64 v56, v[24:25] offset:1024
    ds_write_b64 v56, v[28:29] offset:1032
    s_mov_b32 exec_lo, 0xffff
    s_mov_b32 exec_hi, 0x0
    ds_write_b32 v59, v18
    s_mov_b64 exec, -1
    s_waitcnt lgkmcnt(0)
    s_barrier
    s_cmp_lt_u32 s36, 4
    s_cbranch_scc1 L_a_lw
    ds_read_b128 v[32:35], v43
    ds_read_b128 v[36:39], v43 offset:16
    ds_read_b128 v[160:163], v42 offset:0
    ds_read_b128 v[164:167], v42 offset:1024
    ds_read_b128 v[168:171], v42 offset:2048
    ds_read_b128 v[172:175], v42 offset:3072
    ds_read_b128 v[176:179], v42 offset:4096
    ds_read_b128 v[180:183], v42 offset:5120
    ds_read_b128 v[184:187], v42 offset:6144
    ds_read_b128 v[188:191], v42 offset:7168
    ds_read_b128 v[192:195], v42 offset:8192
    ds_read_b128 v[196:199], v42 offset:9216
    ds_read_b128 v[200:203], v42 offset:10240
    ds_read_b128 v[204:207], v42 offset:11264
    s_waitcnt lgkmcnt(12)
    v_max3_f32 v20, v32, v33, v34
    v_max3_f32 v20, v20, v35, v36
    v_max3_f32 v20, v20, v37, v38
    v_max_f32 v20, v20, v39
    v_sub_f32 v32, v32, v20
    v_sub_f32 v33, v33, v20
    v_sub_f32 v34, v34, v20
    v_sub_f32 v35, v35, v20
    v_sub_f32 v36, v36, v20
    v_sub_f32 v37, v37, v20
    v_sub_f32 v38, v38, v20
    v_sub_f32 v39, v39, v20
    s_waitcnt lgkmcnt(10)
    v_mfma_f32_16x16x32_bf16 v[224:227], v[96:99], v[160:163], 0
    v_mfma_f32_16x16x32_bf16 v[224:227], v[100:103], v[164:167], v[224:227]
    ds_read_b128 v[208:211], v42 offset:12288
    ds_read_b128 v[212:215], v42 offset:13312
    v_exp_f32 v32, v32
    s_waitcnt lgkmcnt(10)
    v_mfma_f32_16x16x32_bf16 v[228:231], v[104:107], v[168:171], 0
    v_mfma_f32_16x16x32_bf16 v[228:231], v[108:111], v[172:175], v[228:231]
    ds_read_b128 v[216:219], v42 offset:14336
    ds_read_b128 v[220:223], v42 offset:15360
    v_exp_f32 v33, v33
    s_waitcnt lgkmcnt(10)
    v_mfma_f32_16x16x32_bf16 v[232:235], v[112:115], v[176:179], 0
    v_mfma_f32_16x16x32_bf16 v[232:235], v[116:119], v[180:183], v[232:235]
    v_exp_f32 v34, v34
    v_mul_f32 v236, v224, v32
    v_mul_f32 v237, v225, v32
    v_mul_f32 v238, v226, v32
    v_mul_f32 v239, v227, v32
    s_waitcnt lgkmcnt(8)
    v_mfma_f32_16x16x32_bf16 v[224:227], v[120:123], v[184:187], 0
    v_mfma_f32_16x16x32_bf16 v[224:227], v[124:127], v[188:191], v[224:227]
    v_exp_f32 v35, v35
    v_fma_f32 v236, v228, v33, v236
    v_fma_f32 v237, v229, v33, v237
    v_fma_f32 v238, v230, v33, v238
    v_fma_f32 v239, v231, v33, v239
    s_waitcnt lgkmcnt(6)
    v_mfma_f32_16x16x32_bf16 v[228:231], v[128:131], v[192:195], 0
    v_mfma_f32_16x16x32_bf16 v[228:231], v[132:135], v[196:199], v[228:231]
    v_exp_f32 v36, v36
    v_fma_f32 v236, v232, v34, v236
    v_fma_f32 v237, v233, v34, v237
    v_fma_f32 v238, v234, v34, v238
    v_fma_f32 v239, v235, v34, v239
    s_waitcnt lgkmcnt(4)
    v_mfma_f32_16x16x32_bf16 v[232:235], v[136:139], v[200:203], 0
    v_mfma_f32_16x16x32_bf16 v[232:235], v[140:143], v[204:207], v[232:235]
    v_exp_f32 v37, v37
    v_fma_f32 v236, v224, v35, v236
    v_fma_f32 v237, v225, v35, v237
    v_fma_f32 v238, v226, v35, v238
    v_fma_f32 v239, v227, v35, v239
    s_waitcnt lgkmcnt(2)
    v_mfma_f32_16x16x32_bf16 v[224:227], v[144:147], v[208:211], 0
    v_mfma_f32_16x16x32_bf16 v[224:227], v[148:151], v[212:215], v[224:227]
    v_exp_f32 v38, v38
    v_fma_f32 v236, v228, v36, v236
    v_fma_f32 v237, v229, v36, v237
    v_fma_f32 v238, v230, v36, v238
    v_fma_f32 v239, v231, v36, v239
    s_waitcnt lgkmcnt(0)
    v_mfma_f32_16x16x32_bf16 v[228:231], v[152:155], v[216:219], 0
    v_mfma_f32_16x16x32_bf16 v[228:231], v[156:159], v[220:223], v[228:231]
    v_exp_f32 v39, v39
    v_fma_f32 v236, v232, v37, v236
    v_fma_f32 v237, v233, v37, v237
    v_fma_f32 v238, v234, v37, v238
    v_fma_f32 v239, v235, v37, v239
    v_fma_f32 v236, v224, v38, v236
    v_fma_f32 v237, v225, v38, v237
    v_fma_f32 v238, v226, v38, v238
    v_fma_f32 v239, v227, v38, v239
    s_nop 0
    v_fma_f32 v236, v228, v39, v236
    v_fma_f32 v237, v229, v39, v237
    v_fma_f32 v238, v230, v39, v238
    v_fma_f32 v239, v231, v39, v239
    v_cvt_pk_bf16_f32 v48, v236, v237
    v_cvt_pk_bf16_f32 v49, v238, v239
    global_store_dwordx4 v244, v[48:51], s[32:33] sc1
L_a_s4:
    s_barrier
    global_load_dwordx4 v[64:67], v254, s[96:97]
    s_add_u32 s96, s96, 32768
    s_addc_u32 s97, s97, 0
    global_load_dwordx4 v[68:71], v254, s[96:97]
    s_add_u32 s96, s96, 32768
    s_addc_u32 s97, s97, 0
    global_load_dwordx4 v[72:75], v254, s[96:97]
    s_add_u32 s96, s96, 32768
    s_addc_u32 s97, s97, 0
    global_load_dwordx4 v[76:79], v254, s[96:97]
    s_mov_b32 s50, 0
    global_load_dwordx4 v[16:19], v245, s[32:33] sc1
ox_top_22:
    s_waitcnt vmcnt(0)
    v_cmp_ne_u32 s[10:11], s39, v19
    s_cmp_lg_u64 s[10:11], 0
    s_cbranch_scc1 ox_retry_24
ox_done_23:
    v_max_f32_dpp v22, v16, v16 row_ror:4 row_mask:0xf bank_mask:0xf
    s_nop 1
    v_max_f32_dpp v22, v22, v22 row_ror:8 row_mask:0xf bank_mask:0xf
    s_nop 0
    v_mov_b32 v23, v22
    s_nop 1
    v_permlane16_swap_b32 v23, v22
    s_nop 0
    v_max_f32 v22, v22, v23
    v_sub_f32 v24, v16, v22
    v_exp_f32 v24, v24
    v_permlane32_swap_b32 v16, v17
    s_nop 0
    v_mul_f32 v22, v24, v17
    v_lshlrev_b32 v25, 16, v16
    v_add_f32_dpp v22, v22, v22 row_ror:4 row_mask:0xf bank_mask:0xf
    v_and_b32 v26, 0xffff0000, v16
    s_nop 0
    v_add_f32_dpp v22, v22, v22 row_ror:8 row_mask:0xf bank_mask:0xf
    s_nop 0
    v_mov_b32 v23, v22
    s_nop 1
    v_permlane16_swap_b32 v23, v22
    s_nop 0
    v_add_f32 v22, v22, v23
    v_rcp_f32 v22, v22
    s_nop 0
    v_mul_f32 v24, v24, v22
    v_mov_b32 v23, v24
    s_nop 1
    v_permlane32_swap_b32 v23, v24
    s_nop 0
    v_mul_f32 v25, v25, v24
    v_mul_f32 v26, v26, v24
    s_nop 1
    v_permlane16_swap_b32 v25, v26
    s_nop 0
    v_add_f32 v25, v25, v26
    s_nop 1
    v_add_f32_dpp v25, v25, v25 row_ror:4 row_mask:0xf bank_mask:0xf
    s_nop 1
    v_add_f32_dpp v25, v25, v25 row_ror:8 row_mask:0xf bank_mask:0xf
    v_cvt_pk_bf16_f32 v25, v25, v25
    s_nop 1
    v_and_b32_dpp v84, v25, v240 quad_perm:[0,0,0,0] row_mask:0xf bank_mask:0xf
    v_and_b32_dpp v85, v25, v241 quad_perm:[0,0,0,0] row_mask:0xf bank_mask:0xf
    v_and_b32_dpp v86, v25, v242 quad_perm:[0,0,0,0] row_mask:0xf bank_mask:0xf
    v_and_b32_dpp v87, v25, v243 quad_perm:[0,0,0,0] row_mask:0xf bank_mask:0xf
    v_and_b32_dpp v88, v25, v240 quad_perm:[1,1,1,1] row_mask:0xf bank_mask:0xf
    v_and_b32_dpp v89, v25, v241 quad_perm:[1,1,1,1] row_mask:0xf bank_mask:0xf
    v_and_b32_dpp v90, v25, v242 quad_perm:[1,1,1,1] row_mask:0xf bank_mask:0xf
    v_and_b32_dpp v91, v25, v243 quad_perm:[1,1,1,1] row_mask:0xf bank_mask:0xf
    v_mfma_f32_16x16x32_bf16 v[92:95], v[84:87], v[64:67], 0
    v_and_b32_dpp v84, v25, v240 quad_perm:[2,2,2,2] row_mask:0xf bank_mask:0xf
    v_and_b32_dpp v85, v25, v241 quad_perm:[2,2,2,2] row_mask:0xf bank_mask:0xf
    v_and_b32_dpp v86, v25, v242 quad_perm:[2,2,2,2] row_mask:0xf bank_mask:0xf
    v_and_b32_dpp v87, v25, v243 quad_perm:[2,2,2,2] row_mask:0xf bank_mask:0xf
    v_mfma_f32_16x16x32_bf16 v[92:95], v[88:91], v[68:71], v[92:95]
    v_and_b32_dpp v88, v25, v240 quad_perm:[3,3,3,3] row_mask:0xf bank_mask:0xf
    v_and_b32_dpp v89, v25, v241 quad_perm:[3,3,3,3] row_mask:0xf bank_mask:0xf
    v_and_b32_dpp v90, v25, v242 quad_perm:[3,3,3,3] row_mask:0xf bank_mask:0xf
    v_and_b32_dpp v91, v25, v243 quad_perm:[3,3,3,3] row_mask:0xf bank_mask:0xf
    v_mfma_f32_16x16x32_bf16 v[92:95], v[84:87], v[72:75], v[92:95]
    s_nop 1
    v_mfma_f32_16x16x32_bf16 v[92:95], v[88:91], v[76:79], v[92:95]
    s_mov_b32 exec_lo, 0xffffffff
    s_mov_b32 exec_hi, 0x0
    s_nop 5
    ds_write_b128 v247, v[92:95] offset:3072
    s_mov_b64 exec, -1
    s_waitcnt lgkmcnt(0)
    s_barrier
    s_cmp_eq_u32 s36, 0
    s_cbranch_scc0 L_a_red
    ds_read_b64 v[32:33], v57 offset:3072
    ds_read_b64 v[34:35], v57 offset:3584
    ds_read_b64 v[36:37], v57 offset:4096
    ds_read_b64 v[38:39], v57 offset:4608
    ds_read_b64 v[40:41], v57 offset:5120
    ds_read_b64 v[42:43], v57 offset:5632
    ds_read_b64 v[44:45], v57 offset:6144
    ds_read_b64 v[46:47], v57 offset:6656
    v_mov_b32 v23, s39
    s_waitcnt lgkmcnt(0)
    v_pk_add_f32 v[32:33], v[32:33], v[34:35]
    v_pk_add_f32 v[36:37], v[36:37], v[38:39]
    v_pk_add_f32 v[40:41], v[40:41], v[42:43]
    v_pk_add_f32 v[44:45], v[44:45], v[46:47]
    v_pk_add_f32 v[32:33], v[32:33], v[36:37]
    v_pk_add_f32 v[40:41], v[40:41], v[44:45]
    v_pk_add_f32 v[32:33], v[32:33], v[40:41]
    v_cvt_pk_bf16_f32 v20, v32, v33
    s_nop 1
    v_mov_b32_dpp v21, v20 row_shl:1 row_mask:0xf bank_mask:0xf
    s_mov_b32 exec_lo, 0x55555555
    s_mov_b32 exec_hi, 0x55555555
    s_cmp_eq_u32 s59, 1
    s_cbranch_scc0 ms_slow_25
    global_store_dwordx4 v253, v[20:23], s[32:33]
ms_done_26:
    s_mov_b64 exec, -1
L_a_red:
    s_cmp_eq_u32 s36, 7
    s_cbranch_scc0 L_fin
    s_cmp_lt_u32 s35, 10
    s_cbranch_scc0 L_fin
    s_mul_i32 s55, s34, 10
    s_add_u32 s55, s55, s35
    v_and_b32 v7, 3, v0
    v_lshrrev_b32 v6, 5, v0
    v_lshl_add_u32 v8, v7, 1, v6
    s_lshl_b32 s48, s55, 3
    v_add_u32 v31, s48, v8
    v_lshlrev_b32 v31, 1, v31
    global_load_ushort v30, v31, s[8:9]
    v_and_b32 v9, 7, v0
    v_mul_u32_u24 v9, 2560, v9
    v_bfe_u32 v10, v0, 3, 1
    v_lshl_add_u32 v9, v10, 4, v9
    s_lshr_b32 s48, s55, 4
    s_lshl_b32 s48, s48, 9
    s_and_b32 s49, s55, 15
    s_lshl_b32 s49, s49, 5
    s_add_u32 s48, s48, s49
    s_add_u32 s48, s48, 950272
    v_add_u32 v9, s48, v9
    s_lshl_b32 s48, s55, 6
    s_add_u32 s48, s48, 1048576
    v_lshrrev_b32 v12, 2, v0
    v_mul_u32_u24 v12, 5120, v12
    v_lshl_add_u32 v12, v7, 4, v12
    v_add_u32 v12, s48, v12
    v_add_u32 v13, 81920, v12
    v_add_u32 v14, 163840, v12
    v_add_u32 v15, 245760, v12
    v_mov_b32 v44, s39
    v_mov_b32 v46, 0
    v_mov_b32 v47, 0
    v_mov_b32 v19, s39
    v_mov_b32 v16, 0
    v_mov_b32 v17, 0
    v_lshrrev_b32 v28, 2, v8
    v_lshlrev_b32 v28, 5, v28
    v_and_b32 v29, 3, v8
    s_mov_b32 s50, 0
    s_mov_b32 exec_lo, 0xffff
    s_mov_b32 exec_hi, 0x0
    global_load_dwordx4 v[16:19], v9, s[32:33] sc1
    s_mov_b64 exec, -1
hf_top_27:
    s_waitcnt vmcnt(0)
    v_cmp_ne_u32 s[10:11], s39, v19
    s_cmp_lg_u64 s[10:11], 0
    s_cbranch_scc1 hf_retry_29
hf_done_28:
    v_lshlrev_b32 v20, 16, v16
    v_and_b32 v21, 0xffff0000, v16
    v_lshlrev_b32 v22, 16, v17
    v_and_b32 v23, 0xffff0000, v17
    s_nop 0
    v_add_f32_dpp v20, v20, v20 quad_perm:[1,0,3,2] row_mask:0xf bank_mask:0xf
    v_add_f32_dpp v21, v21, v21 quad_perm:[1,0,3,2] row_mask:0xf bank_mask:0xf
    v_add_f32_dpp v22, v22, v22 quad_perm:[1,0,3,2] row_mask:0xf bank_mask:0xf
    v_add_f32_dpp v23, v23, v23 quad_perm:[1,0,3,2] row_mask:0xf bank_mask:0xf
    s_nop 0
    v_add_f32_dpp v20, v20, v20 quad_perm:[2,3,0,1] row_mask:0xf bank_mask:0xf
    v_add_f32_dpp v21, v21, v21 quad_perm:[2,3,0,1] row_mask:0xf bank_mask:0xf
    v_add_f32_dpp v22, v22, v22 quad_perm:[2,3,0,1] row_mask:0xf bank_mask:0xf
    v_add_f32_dpp v23, v23, v23 quad_perm:[2,3,0,1] row_mask:0xf bank_mask:0xf
    s_nop 0
    v_add_f32_dpp v20, v20, v20 row_half_mirror row_mask:0xf bank_mask:0xf
    v_add_f32_dpp v21, v21, v21 row_half_mirror row_mask:0xf bank_mask:0xf
    v_add_f32_dpp v22, v22, v22 row_half_mirror row_mask:0xf bank_mask:0xf
    v_add_f32_dpp v23, v23, v23 row_half_mirror row_mask:0xf bank_mask:0xf
    s_nop 0
    ds_bpermute_b32 v24, v28, v20
    ds_bpermute_b32 v25, v28, v21
    ds_bpermute_b32 v26, v28, v22
    ds_bpermute_b32 v27, v28, v23
    s_waitcnt lgkmcnt(0)
    v_cmp_eq_u32 vcc, 1, v29
    s_nop 0
    v_cndmask_b32 v24, v24, v25, vcc
    v_cmp_eq_u32 vcc, 2, v29
    s_nop 0
    v_cndmask_b32 v24, v24, v26, vcc
    v_cmp_eq_u32 vcc, 3, v29
    s_nop 0
    v_cndmask_b32 v16, v24, v27, vcc
    v_cvt_pk_bf16_f32 v16, v16, v16
    v_and_b32 v16, 0xffff0000, v16
    v_lshlrev_b32 v30, 16, v30
    v_add_f32 v30, v30, v16
    v_cvt_pk_bf16_f32 v30, v30, v30
    v_and_b32 v30, 0xffff0000, v30
    s_mov_b32 s50, 0
    global_load_dwordx4 v[32:35], v12, s[32:33] sc1
    global_load_dwordx4 v[36:39], v13, s[32:33] sc1
    global_load_dwordx4 v[40:43], v14, s[32:33] sc1
    s_mov_b32 exec_lo, 0xffffff
    s_mov_b32 exec_hi, 0x0
    global_load_dwordx4 v[44:47], v15, s[32:33] sc1
    s_mov_b64 exec, -1
o2_top_30:
    s_waitcnt vmcnt(0)
    v_cmp_ne_u32 s[10:11], s39, v32
    v_cmp_ne_u32 s[12:13], s39, v36
    v_cmp_ne_u32 s[14:15], s39, v40
    v_cmp_ne_u32 s[18:19], s39, v44
    s_or_b64 s[46:47], s[10:11], s[12:13]
    s_or_b64 s[46:47], s[46:47], s[14:15]
    s_or_b64 s[46:47], s[46:47], s[18:19]
    s_cbranch_scc1 o2_retry_32
o2_done_31:
    v_pk_add_f32 v[16:17], v[34:35], v[38:39]
    v_pk_add_f32 v[18:19], v[42:43], v[46:47]
    v_pk_add_f32 v[16:17], v[16:17], v[18:19]
    s_nop 1
    v_permlane32_swap_b32 v16, v17
    s_nop 0
    v_add_f32 v16, v16, v17
    v_mov_b32 v17, v16
    s_nop 1
    v_permlane16_swap_b32 v17, v16
    s_nop 0
    v_add_f32 v16, v16, v17
    s_nop 1
    v_add_f32_dpp v16, v16, v16 row_ror:4 row_mask:0xf bank_mask:0xf
    s_nop 1
    v_add_f32_dpp v16, v16, v16 row_ror:8 row_mask:0xf bank_mask:0xf
    v_cvt_pk_bf16_f32 v16, v16, v16
    v_and_b32 v16, 0xffff0000, v16
    v_add_f32 v16, v16, v30
    v_cvt_pk_bf16_f32 v16, v16, v16
    s_mov_b32 exec_lo, 0xf
    s_mov_b32 exec_hi, 0xf
    global_store_short v31, v16, s[28:29]
    s_mov_b64 exec, -1
    s_cmp_eq_u32 s55, 0
    s_cbranch_scc0 L_fin
    s_mov_b64 exec, 1
    v_mov_b32 v2, s39
    global_store_dword v1, v2, s[32:33] sc1
    s_mov_b64 exec, -1
    s_branch L_fin
L_pathB:
    s_sub_u32 s54, s35, 16
    s_lshr_b32 s48, s54, 2
    s_lshl_b32 s49, s34, 2
    s_add_u32 s55, s48, s49
    s_cmp_eq_u32 s36, 0
    s_cbranch_scc0 L_b1
    s_lshl_b32 s48, s55, 13
    s_add_u32 s49, s48, 65536
    s_add_u32 s40, s32, s49
    s_addc_u32 s41, s33, 0
    s_add_u32 s49, s48, 327680
    s_add_u32 s42, s32, s49
    s_addc_u32 s43, s33, 0
    v_add_u32 v4, 4096, v3
    v_and_b32 v14, 1, v6
    v_lshlrev_b32 v14, 3, v14
    v_lshl_add_u32 v14, v7, 4, v14
    v_lshrrev_b32 v15, 1, v6
    v_lshl_add_u32 v14, v15, 2, v14
    s_mov_b32 s50, 0
    global_load_dwordx4 v[32:35], v3, s[40:41] offset:0 sc1
    global_load_dwordx4 v[36:39], v3, s[40:41] offset:1024 sc1
    global_load_dwordx4 v[40:43], v3, s[40:41] offset:2048 sc1
    global_load_dwordx4 v[44:47], v3, s[40:41] offset:3072 sc1
    global_load_dwordx4 v[48:51], v4, s[40:41] offset:0 sc1
    global_load_dwordx4 v[52:55], v4, s[40:41] offset:1024 sc1
    global_load_dwordx4 v[56:59], v4, s[40:41] offset:2048 sc1
    global_load_dwordx4 v[60:63], v4, s[40:41] offset:3072 sc1
q1_top_37:
    s_waitcnt vmcnt(0)
    v_cmp_ne_u32 s[10:11], s39, v35
    v_cmp_ne_u32 s[12:13], s39, v39
    v_cmp_ne_u32 s[14:15], s39, v43
    v_cmp_ne_u32 s[4:5], s39, v47
    v_cmp_ne_u32 s[20:21], s39, v51
    v_cmp_ne_u32 s[96:97], s39, v55
    v_cmp_ne_u32 s[98:99], s39, v59
    v_cmp_ne_u32 s[100:101], s39, v63
    s_or_b64 s[46:47], s[10:11], s[12:13]
    s_or_b64 s[46:47], s[46:47], s[14:15]
    s_or_b64 s[46:47], s[46:47], s[4:5]
    s_or_b64 s[46:47], s[46:47], s[20:21]
    s_or_b64 s[46:47], s[46:47], s[96:97]
    s_or_b64 s[46:47], s[46:47], s[98:99]
    s_or_b64 s[46:47], s[46:47], s[100:101]
    s_cbranch_scc1 q1_retry_39
q1_done_38:
    v_pk_add_f32 v[12:13], v[32:33], v[36:37]
    v_pk_add_f32 v[10:11], v[40:41], v[44:45]
    v_pk_add_f32 v[16:17], v[48:49], v[52:53]
    v_pk_add_f32 v[18:19], v[56:57], v[60:61]
    v_pk_add_f32 v[12:13], v[12:13], v[10:11]
    v_pk_add_f32 v[16:17], v[16:17], v[18:19]
    v_pk_add_f32 v[12:13], v[12:13], v[16:17]
    v_cvt_pk_bf16_f32 v12, v12, v13
    ds_write_b32 v14, v12 offset:256
    s_waitcnt lgkmcnt(0)
    s_barrier
    s_branch L_b2
L_b1:
    s_lshl_b32 s48, s55, 11
    s_and_b32 s49, s54, 3
    s_lshl_b32 s49, s49, 9
    s_add_u32 s48, s48, s49
    s_and_b32 s49, s36, 3
    s_lshl_b32 s49, s49, 7
    s_add_u32 s48, s48, s49
    s_add_u32 s48, s48, 589824
    v_lshlrev_b32 v9, 4, v6
    v_lshl_add_u32 v104, v7, 6, v9
    s_mov_b32 s56, 0x00020002
    s_mov_b32 s57, 0x00020002
    v_add_u32 v104, s48, v104
    v_mov_b32 v103, s39
    s_cmp_ge_u32 s36, 4
    s_cbranch_scc0 L_b1x
    s_and_b32 s49, s36, 3
    s_lshl_b32 s49, s49, 13
    s_add_u32 s49, s49, 59392
    v_lshl_add_u32 v12, v7, 8, s49
    v_add_u32 v13, 0, v6
    v_xor_b32 v13, v13, v7
    v_lshl_add_u32 v13, v13, 4, v12
    ds_read_b128 v[64:67], v13 offset:0
    ds_read_b128 v[80:83], v13 offset:4096
    v_add_u32 v13, 4, v6
    v_xor_b32 v13, v13, v7
    v_lshl_add_u32 v13, v13, 4, v12
    ds_read_b128 v[68:71], v13 offset:0
    ds_read_b128 v[84:87], v13 offset:4096
    v_add_u32 v13, 8, v6
    v_xor_b32 v13, v13, v7
    v_lshl_add_u32 v13, v13, 4, v12
    ds_read_b128 v[72:75], v13 offset:0
    ds_read_b128 v[88:91], v13 offset:4096
    v_add_u32 v13, 12, v6
    v_xor_b32 v13, v13, v7
    v_lshl_add_u32 v13, v13, 4, v12
    ds_read_b128 v[76:79], v13 offset:0
    ds_read_b128 v[92:95], v13 offset:4096
    s_waitcnt lgkmcnt(0)
    s_barrier
    ds_read_b128 v[108:111], v9 offset:256
    ds_read_b128 v[112:115], v9 offset:320
    ds_read_b128 v[116:119], v9 offset:384
    ds_read_b128 v[120:123], v9 offset:448
    s_waitcnt lgkmcnt(3)
    v_mfma_f32_16x16x32_bf16 v[124:127], v[64:67], v[108:111], 0
    v_mfma_f32_16x16x32_bf16 v[128:131], v[80:83], v[108:111], 0
    s_waitcnt lgkmcnt(2)
    v_mfma_f32_16x16x32_bf16 v[124:127], v[68:71], v[112:115], v[124:127]
    v_mfma_f32_16x16x32_bf16 v[128:131], v[84:87], v[112:115], v[128:131]
    s_waitcnt lgkmcnt(1)
    v_mfma_f32_16x16x32_bf16 v[124:127], v[72:75], v[116:119], v[124:127]
    v_mfma_f32_16x16x32_bf16 v[128:131], v[88:91], v[116:119], v[128:131]
    s_waitcnt lgkmcnt(0)
    v_mfma_f32_16x16x32_bf16 v[124:127], v[76:79], v[120:123], v[124:127]
    v_mfma_f32_16x16x32_bf16 v[128:131], v[92:95], v[120:123], v[128:131]
    s_mov_b32 exec_lo, 0x00030003
    s_mov_b32 exec_hi, 0x00030003
    s_nop 5
    v_cvt_pk_bf16_f32 v96, v124, v125
    v_cvt_pk_bf16_f32 v97, v126, v127
    v_cvt_pk_bf16_f32 v98, v128, v129
    v_cvt_pk_bf16_f32 v99, v130, v131
    v_cndmask_b32 v100, v96, v98, s[56:57]
    v_cndmask_b32 v101, v97, v99, s[56:57]
    global_store_dwordx4 v104, v[100:103], s[32:33] sc1
    s_mov_b64 exec, -1
L_b2:
    s_barrier
    v_lshrrev_b32 v8, 3, v7
    v_and_b32 v9, 7, v0
    v_lshl_add_u32 v10, v8, 2, v6
    s_cmp_lt_u32 s54, 5
    s_cbranch_scc1 L_b_wo
    s_cmp_ge_u32 s54, 12
    s_cbranch_scc1 L_b_help
    s_sub_u32 s48, s54, 5
    s_mul_i32 s49, s34, 7
    s_add_u32 s58, s49, s48
    s_cmp_lt_u32 s58, 54
    s_cbranch_scc0 L_fin
    s_branch L_b_mlpld
L_b_help:
    s_sub_u32 s48, s54, 12
    s_lshl_b32 s49, s34, 2
    s_add_u32 s48, s48, s49
    s_lshl_b32 s48, s48, 8
    s_lshl_b32 s49, s36, 19
    s_add_u32 s48, s48, s49
    s_add_u32 s40, s16, s48
    s_addc_u32 s41, s17, 0
    v_lshlrev_b32 v11, 13, v6
    v_lshl_add_u32 v11, v7, 4, v11
    global_load_dwordx4 v[64:67], v11, s[40:41]
    s_add_u32 s40, s40, 32768
    s_addc_u32 s41, s41, 0
    global_load_dwordx4 v[68:71], v11, s[40:41]
    s_add_u32 s40, s40, 32768
    s_addc_u32 s41, s41, 0
    global_load_dwordx4 v[72:75], v11, s[40:41]
    s_add_u32 s40, s40, 32768
    s_addc_u32 s41, s41, 0
    global_load_dwordx4 v[76:79], v11, s[40:41]
    s_add_u32 s40, s40, 32768
    s_addc_u32 s41, s41, 0
    global_load_dwordx4 v[80:83], v11, s[40:41]
    s_add_u32 s40, s40, 32768
    s_addc_u32 s41, s41, 0
    global_load_dwordx4 v[84:87], v11, s[40:41]
    s_add_u32 s40, s40, 32768
    s_addc_u32 s41, s41, 0
    global_load_dwordx4 v[88:91], v11, s[40:41]
    s_add_u32 s40, s40, 32768
    s_addc_u32 s41, s41, 0
    global_load_dwordx4 v[92:95], v11, s[40:41]
    s_add_u32 s40, s40, 32768
    s_addc_u32 s41, s41, 0
    global_load_dwordx4 v[96:99], v11, s[40:41]
    s_add_u32 s40, s40, 32768
    s_addc_u32 s41, s41, 0
    global_load_dwordx4 v[100:103], v11, s[40:41]
    s_add_u32 s40, s40, 32768
    s_addc_u32 s41, s41, 0
    global_load_dwordx4 v[104:107], v11, s[40:41]
    s_add_u32 s40, s40, 32768
    s_addc_u32 s41, s41, 0
    global_load_dwordx4 v[108:111], v11, s[40:41]
    s_add_u32 s40, s40, 32768
    s_addc_u32 s41, s41, 0
    global_load_dwordx4 v[112:115], v11, s[40:41]
    s_add_u32 s40, s40, 32768
    s_addc_u32 s41, s41, 0
    global_load_dwordx4 v[116:119], v11, s[40:41]
    s_add_u32 s40, s40, 32768
    s_addc_u32 s41, s41, 0
    global_load_dwordx4 v[120:123], v11, s[40:41]
    s_add_u32 s40, s40, 32768
    s_addc_u32 s41, s41, 0
    global_load_dwordx4 v[124:127], v11, s[40:41]
    s_waitcnt vmcnt(0)
    s_branch L_fin
L_b_wo:
    s_lshl_b32 s48, s34, 3
    s_add_u32 s48, s48, s36
    s_mul_i32 s48, s48, 81920
    s_lshl_b32 s49, s54, 8
    s_add_u32 s48, s48, s49
    s_add_u32 s40, s18, s48
    s_addc_u32 s41, s19, 0
    v_mul_u32_u24 v11, 1280, v6
    v_lshl_add_u32 v11, v7, 4, v11
    global_load_dwordx4 v[32:35], v11, s[40:41]
    s_add_u32 s40, s40, 5120
    s_addc_u32 s41, s41, 0
    global_load_dwordx4 v[36:39], v11, s[40:41]
    s_add_u32 s40, s40, 5120
    s_addc_u32 s41, s41, 0
    global_load_dwordx4 v[40:43], v11, s[40:41]
    s_add_u32 s40, s40, 5120
    s_addc_u32 s41, s41, 0
    global_load_dwordx4 v[44:47], v11, s[40:41]
    s_add_u32 s40, s40, 5120
    s_addc_u32 s41, s41, 0
    global_load_dwordx4 v[48:51], v11, s[40:41]
    s_add_u32 s40, s40, 5120
    s_addc_u32 s41, s41, 0
    global_load_dwordx4 v[52:55], v11, s[40:41]
    s_add_u32 s40, s40, 5120
    s_addc_u32 s41, s41, 0
    global_load_dwordx4 v[56:59], v11, s[40:41]
    s_add_u32 s40, s40, 5120
    s_addc_u32 s41, s41, 0
    global_load_dwordx4 v[60:63], v11, s[40:41]
    s_add_u32 s40, s40, 5120
    s_addc_u32 s41, s41, 0
    global_load_dwordx4 v[64:67], v11, s[40:41]
    s_add_u32 s40, s40, 5120
    s_addc_u32 s41, s41, 0
    global_load_dwordx4 v[68:71], v11, s[40:41]
    s_add_u32 s40, s40, 5120
    s_addc_u32 s41, s41, 0
    global_load_dwordx4 v[72:75], v11, s[40:41]
    s_add_u32 s40, s40, 5120
    s_addc_u32 s41, s41, 0
    global_load_dwordx4 v[76:79], v11, s[40:41]
    s_add_u32 s40, s40, 5120
    s_addc_u32 s41, s41, 0
    global_load_dwordx4 v[80:83], v11, s[40:41]
    s_add_u32 s40, s40, 5120
    s_addc_u32 s41, s41, 0
    global_load_dwordx4 v[84:87], v11, s[40:41]
    s_add_u32 s40, s40, 5120
    s_addc_u32 s41, s41, 0
    global_load_dwordx4 v[88:91], v11, s[40:41]
    s_add_u32 s40, s40, 5120
    s_addc_u32 s41, s41, 0
    global_load_dwordx4 v[92:95], v11, s[40:41]
    v_and_b32 v16, 7, v0
    v_and_b32 v17, 1, v0
    v_cmp_eq_u32 vcc, 1, v17
    v_mov_b32 v192, 0xffff
    v_mov_b32 v193, 0xffff0000
    v_cndmask_b32 v17, v192, v193, vcc
    v_lshrrev_b32 v16, 1, v16
    v_cmp_eq_u32 vcc, 0, v16
    s_nop 0
    v_cndmask_b32 v192, 0, v17, vcc
    v_cmp_eq_u32 vcc, 1, v16
    s_nop 0
    v_cndmask_b32 v193, 0, v17, vcc
    v_cmp_eq_u32 vcc, 2, v16
    s_nop 0
    v_cndmask_b32 v194, 0, v17, vcc
    v_cmp_eq_u32 vcc, 3, v16
    s_nop 0
    v_cndmask_b32 v195, 0, v17, vcc
    s_lshr_b32 s48, s36, 1
    s_lshl_b32 s48, s48, 2
    s_lshl_b32 s49, s34, 4
    s_add_u32 s48, s48, s49
    s_lshl_b32 s48, s48, 9
    s_and_b32 s49, s36, 1
    s_lshl_b32 s49, s49, 8
    s_add_u32 s48, s48, s49
    s_add_u32 s48, s48, 688128
    v_lshlrev_b32 v11, 9, v6
    v_lshl_add_u32 v11, v7, 4, v11
    v_add_u32 v11, s48, v11
    v_lshlrev_b32 v26, 5, v7
    v_lshl_add_u32 v26, v6, 4, v26
    s_lshl_b32 s48, s36, 9
    v_add_u32 v26, s48, v26
    v_lshlrev_b32 v28, 3, v0
    s_mul_i32 s48, s34, 2560
    s_lshl_b32 s49, s54, 9
    s_add_u32 s48, s48, s49
    s_add_u32 s48, s48, 950272
    v_lshrrev_b32 v29, 1, v0
    v_lshl_add_u32 v29, v29, 4, s48
    v_mov_b32 v147, s39
    s_mov_b32 s50, 0
    global_load_dwordx4 v[16:19], v11, s[32:33] sc1
c4_top_48:
    s_waitcnt vmcnt(0)
    v_cmp_ne_u32 s[10:11], s39, v19
    s_cmp_lg_u64 s[10:11], 0
    s_cbranch_scc1 c4_retry_50
c4_done_49:
    v_lshlrev_b32 v20, 16, v16
    v_and_b32 v21, 0xffff0000, v16
    v_lshlrev_b32 v22, 16, v17
    v_and_b32 v23, 0xffff0000, v17
    s_nop 0
    v_permlane32_swap_b32 v20, v22
    v_permlane32_swap_b32 v21, v23
    s_nop 0
    v_add_f32 v20, v20, v22
    v_add_f32 v21, v21, v23
    s_nop 1
    v_permlane16_swap_b32 v20, v21
    s_nop 0
    v_add_f32 v20, v20, v21
    v_cvt_pk_bf16_f32 v20, v20, v20
    s_nop 1
    v_and_b32_dpp v224, v20, v192 row_newbcast:0 row_mask:0xf bank_mask:0xf
    v_and_b32_dpp v225, v20, v193 row_newbcast:0 row_mask:0xf bank_mask:0xf
    v_and_b32_dpp v226, v20, v194 row_newbcast:0 row_mask:0xf bank_mask:0xf
    v_and_b32_dpp v227, v20, v195 row_newbcast:0 row_mask:0xf bank_mask:0xf
    v_and_b32_dpp v228, v20, v192 row_newbcast:1 row_mask:0xf bank_mask:0xf
    v_and_b32_dpp v229, v20, v193 row_newbcast:1 row_mask:0xf bank_mask:0xf
    v_and_b32_dpp v230, v20, v194 row_newbcast:1 row_mask:0xf bank_mask:0xf
    v_and_b32_dpp v231, v20, v195 row_newbcast:1 row_mask:0xf bank_mask:0xf
    v_and_b32_dpp v232, v20, v192 row_newbcast:2 row_mask:0xf bank_mask:0xf
    v_and_b32_dpp v233, v20, v193 row_newbcast:2 row_mask:0xf bank_mask:0xf
    v_and_b32_dpp v234, v20, v194 row_newbcast:2 row_mask:0xf bank_mask:0xf
    v_and_b32_dpp v235, v20, v195 row_newbcast:2 row_mask:0xf bank_mask:0xf
    v_mfma_f32_16x16x32_bf16 v[200:203], v[224:227], v[32:35], 0
    v_and_b32_dpp v236, v20, v192 row_newbcast:3 row_mask:0xf bank_mask:0xf
    v_and_b32_dpp v237, v20, v193 row_newbcast:3 row_mask:0xf bank_mask:0xf
    v_and_b32_dpp v238, v20, v194 row_newbcast:3 row_mask:0xf bank_mask:0xf
    v_and_b32_dpp v239, v20, v195 row_newbcast:3 row_mask:0xf bank_mask:0xf
    v_mfma_f32_16x16x32_bf16 v[200:203], v[228:231], v[36:39], v[200:203]
    v_and_b32_dpp v224, v20, v192 row_newbcast:4 row_mask:0xf bank_mask:0xf
    v_and_b32_dpp v225, v20, v193 row_newbcast:4 row_mask:0xf bank_mask:0xf
    v_and_b32_dpp v226, v20, v194 row_newbcast:4 row_mask:0xf bank_mask:0xf
    v_and_b32_dpp v227, v20, v195 row_newbcast:4 row_mask:0xf bank_mask:0xf
    v_mfma_f32_16x16x32_bf16 v[200:203], v[232:235], v[40:43], v[200:203]
    v_and_b32_dpp v228, v20, v192 row_newbcast:5 row_mask:0xf bank_mask:0xf
    v_and_b32_dpp v229, v20, v193 row_newbcast:5 row_mask:0xf bank_mask:0xf
    v_and_b32_dpp v230, v20, v194 row_newbcast:5 row_mask:0xf bank_mask:0xf
    v_and_b32_dpp v231, v20, v195 row_newbcast:5 row_mask:0xf bank_mask:0xf
    v_mfma_f32_16x16x32_bf16 v[200:203], v[236:239], v[44:47], v[200:203]
    v_and_b32_dpp v232, v20, v192 row_newbcast:6 row_mask:0xf bank_mask:0xf
    v_and_b32_dpp v233, v20, v193 row_newbcast:6 row_mask:0xf bank_mask:0xf
    v_and_b32_dpp v234, v20, v194 row_newbcast:6 row_mask:0xf bank_mask:0xf
    v_and_b32_dpp v235, v20, v195 row_newbcast:6 row_mask:0xf bank_mask:0xf
    v_mfma_f32_16x16x32_bf16 v[200:203], v[224:227], v[48:51], v[200:203]
    v_and_b32_dpp v236, v20, v192 row_newbcast:7 row_mask:0xf bank_mask:0xf
    v_and_b32_dpp v237, v20, v193 row_newbcast:7 row_mask:0xf bank_mask:0xf
    v_and_b32_dpp v238, v20, v194 row_newbcast:7 row_mask:0xf bank_mask:0xf
    v_and_b32_dpp v239, v20, v195 row_newbcast:7 row_mask:0xf bank_mask:0xf
    v_mfma_f32_16x16x32_bf16 v[200:203], v[228:231], v[52:55], v[200:203]
    v_and_b32_dpp v224, v20, v192 row_newbcast:8 row_mask:0xf bank_mask:0xf
    v_and_b32_dpp v225, v20, v193 row_newbcast:8 row_mask:0xf bank_mask:0xf
    v_and_b32_dpp v226, v20, v194 row_newbcast:8 row_mask:0xf bank_mask:0xf
    v_and_b32_dpp v227, v20, v195 row_newbcast:8 row_mask:0xf bank_mask:0xf
    v_mfma_f32_16x16x32_bf16 v[200:203], v[232:235], v[56:59], v[200:203]
    v_and_b32_dpp v228, v20, v192 row_newbcast:9 row_mask:0xf bank_mask:0xf
    v_and_b32_dpp v229, v20, v193 row_newbcast:9 row_mask:0xf bank_mask:0xf
    v_and_b32_dpp v230, v20, v194 row_newbcast:9 row_mask:0xf bank_mask:0xf
    v_and_b32_dpp v231, v20, v195 row_newbcast:9 row_mask:0xf bank_mask:0xf
    v_mfma_f32_16x16x32_bf16 v[200:203], v[236:239], v[60:63], v[200:203]
    v_and_b32_dpp v232, v20, v192 row_newbcast:10 row_mask:0xf bank_mask:0xf
    v_and_b32_dpp v233, v20, v193 row_newbcast:10 row_mask:0xf bank_mask:0xf
    v_and_b32_dpp v234, v20, v194 row_newbcast:10 row_mask:0xf bank_mask:0xf
    v_and_b32_dpp v235, v20, v195 row_newbcast:10 row_mask:0xf bank_mask:0xf
    v_mfma_f32_16x16x32_bf16 v[200:203], v[224:227], v[64:67], v[200:203]
    v_and_b32_dpp v236, v20, v192 row_newbcast:11 row_mask:0xf bank_mask:0xf
    v_and_b32_dpp v237, v20, v193 row_newbcast:11 row_mask:0xf bank_mask:0xf
    v_and_b32_dpp v238, v20, v194 row_newbcast:11 row_mask:0xf bank_mask:0xf
    v_and_b32_dpp v239, v20, v195 row_newbcast:11 row_mask:0xf bank_mask:0xf
    v_mfma_f32_16x16x32_bf16 v[200:203], v[228:231], v[68:71], v[200:203]
    v_and_b32_dpp v224, v20, v192 row_newbcast:12 row_mask:0xf bank_mask:0xf
    v_and_b32_dpp v225, v20, v193 row_newbcast:12 row_mask:0xf bank_mask:0xf
    v_and_b32_dpp v226, v20, v194 row_newbcast:12 row_mask:0xf bank_mask:0xf
    v_and_b32_dpp v227, v20, v195 row_newbcast:12 row_mask:0xf bank_mask:0xf
    v_mfma_f32_16x16x32_bf16 v[200:203], v[232:235], v[72:75], v[200:203]
    v_and_b32_dpp v228, v20, v192 row_newbcast:13 row_mask:0xf bank_mask:0xf
    v_and_b32_dpp v229, v20, v193 row_newbcast:13 row_mask:0xf bank_mask:0xf
    v_and_b32_dpp v230, v20, v194 row_newbcast:13 row_mask:0xf bank_mask:0xf
    v_and_b32_dpp v231, v20, v195 row_newbcast:13 row_mask:0xf bank_mask:0xf
    v_mfma_f32_16x16x32_bf16 v[200:203], v[236:239], v[76:79], v[200:203]
    v_and_b32_dpp v232, v20, v192 row_newbcast:14 row_mask:0xf bank_mask:0xf
    v_and_b32_dpp v233, v20, v193 row_newbcast:14 row_mask:0xf bank_mask:0xf
    v_and_b32_dpp v234, v20, v194 row_newbcast:14 row_mask:0xf bank_mask:0xf
    v_and_b32_dpp v235, v20, v195 row_newbcast:14 row_mask:0xf bank_mask:0xf
    v_mfma_f32_16x16x32_bf16 v[200:203], v[224:227], v[80:83], v[200:203]
    v_and_b32_dpp v236, v20, v192 row_newbcast:15 row_mask:0xf bank_mask:0xf
    v_and_b32_dpp v237, v20, v193 row_newbcast:15 row_mask:0xf bank_mask:0xf
    v_and_b32_dpp v238, v20, v194 row_newbcast:15 row_mask:0xf bank_mask:0xf
    v_and_b32_dpp v239, v20, v195 row_newbcast:15 row_mask:0xf bank_mask:0xf
    v_mfma_f32_16x16x32_bf16 v[200:203], v[228:231], v[84:87], v[200:203]
    v_mfma_f32_16x16x32_bf16 v[200:203], v[232:235], v[88:91], v[200:203]
    v_mfma_f32_16x16x32_bf16 v[200:203], v[236:239], v[92:95], v[200:203]
    s_mov_b32 exec_lo, 0xffffffff
    s_mov_b32 exec_hi, 0x0
    s_nop 5
    ds_write_b128 v26, v[200:203] offset:3072
    s_mov_b64 exec, -1
    s_waitcnt lgkmcnt(0)
    s_barrier
    s_cmp_eq_u32 s36, 0
    s_cbranch_scc0 L_fin
    ds_read_b64 v[160:161], v28 offset:3072
    ds_read_b64 v[162:163], v28 offset:3584
    ds_read_b64 v[164:165], v28 offset:4096
    ds_read_b64 v[166:167], v28 offset:4608
    ds_read_b64 v[168:169], v28 offset:5120
    ds_read_b64 v[170:171], v28 offset:5632
    ds_read_b64 v[172:173], v28 offset:6144
    ds_read_b64 v[174:175], v28 offset:6656
    s_waitcnt lgkmcnt(0)
    v_pk_add_f32 v[160:161], v[160:161], v[162:163]
    v_pk_add_f32 v[164:165], v[164:165], v[166:167]
    v_pk_add_f32 v[168:169], v[168:169], v[170:171]
    v_pk_add_f32 v[172:173], v[172:173], v[174:175]
    v_pk_add_f32 v[160:161], v[160:161], v[164:165]
    v_pk_add_f32 v[168:169], v[168:169], v[172:173]
    v_pk_add_f32 v[160:161], v[160:161], v[168:169]
    v_cvt_pk_bf16_f32 v144, v160, v161
    s_nop 1
    v_mov_b32_dpp v145, v144 row_shl:1 row_mask:0xf bank_mask:0xf
    s_mov_b32 exec_lo, 0x55555555
    s_mov_b32 exec_hi, 0x55555555
    global_store_dwordx4 v29, v[144:147], s[32:33] sc1
    s_mov_b64 exec, -1
    s_branch L_fin
L_b_mlpld:
    v_and_b32 v8, 7, v0
    v_xor_b32 v8, v8, v6
    v_cmp_le_u32 vcc, 4, v8
    v_mov_b32 v12, s22
    v_mov_b32 v13, s24
    v_mov_b32 v14, s23
    v_mov_b32 v15, s25
    v_cndmask_b32 v18, v12, v13, vcc
    v_cndmask_b32 v19, v14, v15, vcc
    v_and_b32 v9, 3, v8
    v_lshlrev_b32 v9, 4, v9
    v_lshrrev_b32 v10, 3, v0
    v_mul_u32_u24 v10, 3456, v10
    v_add_u32 v10, v10, v9
    s_lshl_b32 s48, s58, 6
    s_mul_i32 s49, s36, 276480
    s_add_u32 s48, s48, s49
    v_add_u32 v10, s48, v10
    v_add_co_u32 v18, vcc, v18, v10
    s_mul_i32 s49, s36, 10240
    s_add_u32 m0, s49, 10240
    v_addc_co_u32 v19, vcc, 0, v19, vcc
    s_nop 0
    global_load_lds_dwordx4 v[18:19], off
    v_add_co_u32 v18, vcc, 27648, v18
    s_add_u32 m0, m0, 1024
    s_nop 0
    v_addc_co_u32 v19, vcc, 0, v19, vcc
    s_nop 0
    global_load_lds_dwordx4 v[18:19], off
    v_add_co_u32 v18, vcc, 27648, v18
    s_add_u32 m0, m0, 1024
    s_nop 0
    v_addc_co_u32 v19, vcc, 0, v19, vcc
    s_nop 0
    global_load_lds_dwordx4 v[18:19], off
    v_add_co_u32 v18, vcc, 27648, v18
    s_add_u32 m0, m0, 1024
    s_nop 0
    v_addc_co_u32 v19, vcc, 0, v19, vcc
    s_nop 0
    global_load_lds_dwordx4 v[18:19], off
    v_add_co_u32 v18, vcc, 27648, v18
    s_add_u32 m0, m0, 1024
    s_nop 0
    v_addc_co_u32 v19, vcc, 0, v19, vcc
    s_nop 0
    global_load_lds_dwordx4 v[18:19], off
    v_add_co_u32 v18, vcc, 27648, v18
    s_add_u32 m0, m0, 1024
    s_nop 0
    v_addc_co_u32 v19, vcc, 0, v19, vcc
    s_nop 0
    global_load_lds_dwordx4 v[18:19], off
    v_add_co_u32 v18, vcc, 27648, v18
    s_add_u32 m0, m0, 1024
    s_nop 0
    v_addc_co_u32 v19, vcc, 0, v19, vcc
    s_nop 0
    global_load_lds_dwordx4 v[18:19], off
    v_add_co_u32 v18, vcc, 27648, v18
    s_add_u32 m0, m0, 1024
    s_nop 0
    v_addc_co_u32 v19, vcc, 0, v19, vcc
    s_nop 0
    global_load_lds_dwordx4 v[18:19], off
    v_add_co_u32 v18, vcc, 27648, v18
    s_add_u32 m0, m0, 1024
    s_nop 0
    v_addc_co_u32 v19, vcc, 0, v19, vcc
    s_nop 0
    global_load_lds_dwordx4 v[18:19], off
    v_add_co_u32 v18, vcc, 27648, v18
    s_add_u32 m0, m0, 1024
    s_nop 0
    v_addc_co_u32 v19, vcc, 0, v19, vcc
    s_nop 0
    global_load_lds_dwordx4 v[18:19], off
    s_mul_i32 s55, s36, 5
    s_mul_i32 s49, s58, 40960
    s_add_u32 s48, s55, 0
    s_lshl_b32 s48, s48, 6
    v_add_u32 v20, s48, v0
    v_mul_u32_u24 v21, 3277, v20
    v_lshrrev_b32 v21, 18, v21
    v_mul_u32_u24 v22, 80, v21
    v_sub_u32 v22, v20, v22
    v_and_b32 v23, 7, v21
    v_lshlrev_b32 v23, 1, v23
    v_xor_b32 v22, v22, v23
    v_mul_u32_u24 v21, 1280, v21
    v_lshl_add_u32 v21, v22, 4, v21
    v_add_u32 v21, s49, v21
    s_lshl_b32 s48, s48, 4
    s_add_u32 m0, s48, 92160
    s_nop 0
    global_load_lds_dwordx4 v21, s[26:27]
    s_add_u32 s48, s55, 1
    s_lshl_b32 s48, s48, 6
    v_add_u32 v20, s48, v0
    v_mul_u32_u24 v21, 3277, v20
    v_lshrrev_b32 v21, 18, v21
    v_mul_u32_u24 v22, 80, v21
    v_sub_u32 v22, v20, v22
    v_and_b32 v23, 7, v21
    v_lshlrev_b32 v23, 1, v23
    v_xor_b32 v22, v22, v23
    v_mul_u32_u24 v21, 1280, v21
    v_lshl_add_u32 v21, v22, 4, v21
    v_add_u32 v21, s49, v21
    s_lshl_b32 s48, s48, 4
    s_add_u32 m0, s48, 92160
    s_nop 0
    global_load_lds_dwordx4 v21, s[26:27]
    s_add_u32 s48, s55, 2
    s_lshl_b32 s48, s48, 6
    v_add_u32 v20, s48, v0
    v_mul_u32_u24 v21, 3277, v20
    v_lshrrev_b32 v21, 18, v21
    v_mul_u32_u24 v22, 80, v21
    v_sub_u32 v22, v20, v22
    v_and_b32 v23, 7, v21
    v_lshlrev_b32 v23, 1, v23
    v_xor_b32 v22, v22, v23
    v_mul_u32_u24 v21, 1280, v21
    v_lshl_add_u32 v21, v22, 4, v21
    v_add_u32 v21, s49, v21
    s_lshl_b32 s48, s48, 4
    s_add_u32 m0, s48, 92160
    s_nop 0
    global_load_lds_dwordx4 v21, s[26:27]
    s_add_u32 s48, s55, 3
    s_lshl_b32 s48, s48, 6
    v_add_u32 v20, s48, v0
    v_mul_u32_u24 v21, 3277, v20
    v_lshrrev_b32 v21, 18, v21
    v_mul_u32_u24 v22, 80, v21
    v_sub_u32 v22, v20, v22
    v_and_b32 v23, 7, v21
    v_lshlrev_b32 v23, 1, v23
    v_xor_b32 v22, v22, v23
    v_mul_u32_u24 v21, 1280, v21
    v_lshl_add_u32 v21, v22, 4, v21
    v_add_u32 v21, s49, v21
    s_lshl_b32 s48, s48, 4
    s_add_u32 m0, s48, 92160
    s_nop 0
    global_load_lds_dwordx4 v21, s[26:27]
    s_add_u32 s48, s55, 4
    s_lshl_b32 s48, s48, 6
    v_add_u32 v20, s48, v0
    v_mul_u32_u24 v21, 3277, v20
    v_lshrrev_b32 v21, 18, v21
    v_mul_u32_u24 v22, 80, v21
    v_sub_u32 v22, v20, v22
    v_and_b32 v23, 7, v21
    v_lshlrev_b32 v23, 1, v23
    v_xor_b32 v22, v22, v23
    v_mul_u32_u24 v21, 1280, v21
    v_lshl_add_u32 v21, v22, 4, v21
    v_add_u32 v21, s49, v21
    s_lshl_b32 s48, s48, 4
    s_add_u32 m0, s48, 92160
    s_nop 0
    global_load_lds_dwordx4 v21, s[26:27]
    s_lshl_b32 s48, s36, 6
    s_min_u32 s48, s48, 256
    v_and_b32 v17, 31, v0
    v_lshlrev_b32 v17, 1, v17
    v_lshrrev_b32 v29, 5, v0
    v_add_u32 v17, v17, v29
    v_add_u32 v17, s48, v17
    v_lshlrev_b32 v244, 2, v17
    global_load_dword v240, v244, s[8:9]
    global_load_ushort v241, v1, s[8:9]
    v_and_b32 v20, 0xfffffff0, v17
    v_bfe_u32 v21, v17, 1, 2
    v_lshl_add_u32 v20, v21, 2, v20
    v_bfe_u32 v21, v17, 3, 1
    v_lshl_add_u32 v20, v21, 1, v20
    v_and_b32 v21, 1, v17
    v_add_u32 v20, v20, v21
    v_lshlrev_b32 v245, 2, v20
    v_lshrrev_b32 v8, 2, v0
    v_and_b32 v9, 3, v0
    v_and_b32 v10, 1, v9
    v_lshlrev_b32 v10, 2, v10
    s_and_b32 s48, s36, 3
    v_add_u32 v10, s48, v10
    v_bfe_u32 v11, v8, 1, 2
    v_xor_b32 v10, v10, v11
    v_lshlrev_b32 v10, 4, v10
    v_lshl_add_u32 v10, v8, 7, v10
    v_lshrrev_b32 v11, 1, v9
    v_lshl_add_u32 v10, v11, 3, v10
    v_add_u32 v24, 10240, v10
    v_add_u32 v25, 51200, v10
    v_and_b32 v12, 7, v8
    v_lshlrev_b32 v12, 1, v12
    v_mul_u32_u24 v13, 1280, v8
    v_and_b32 v14, 1, v9
    v_lshl_add_u32 v13, v14, 3, v13
    v_lshl_add_u32 v13, v11, 4, v13
    v_add_u32 v13, 92160, v13
    s_mul_i32 s55, s36, 10
    s_add_u32 s48, s55, 0
    s_and_b32 s49, s48, 15
    s_andn2_b32 s48, s48, 15
    v_xor_b32 v14, s49, v12
    v_add_u32 v14, s48, v14
    v_lshl_add_u32 v26, v14, 4, v13
    s_add_u32 s48, s55, 2
    s_and_b32 s49, s48, 15
    s_andn2_b32 s48, s48, 15
    v_xor_b32 v14, s49, v12
    v_add_u32 v14, s48, v14
    v_lshl_add_u32 v27, v14, 4, v13
    s_add_u32 s48, s55, 4
    s_and_b32 s49, s48, 15
    s_andn2_b32 s48, s48, 15
    v_xor_b32 v14, s49, v12
    v_add_u32 v14, s48, v14
    v_lshl_add_u32 v28, v14, 4, v13
    s_add_u32 s48, s55, 6
    s_and_b32 s49, s48, 15
    s_andn2_b32 s48, s48, 15
    v_xor_b32 v14, s49, v12
    v_add_u32 v14, s48, v14
    v_lshl_add_u32 v37, v14, 4, v13
    s_add_u32 s48, s55, 8
    s_and_b32 s49, s48, 15
    s_andn2_b32 s48, s48, 15
    v_xor_b32 v14, s49, v12
    v_add_u32 v14, s48, v14
    v_lshl_add_u32 v38, v14, 4, v13
    v_lshlrev_b32 v31, 4, v6
    s_and_b32 s48, s36, 1
    s_lshl_b32 s48, s48, 4
    s_lshr_b32 s49, s36, 1
    s_and_b32 s49, s49, 1
    s_lshl_b32 s49, s49, 2
    s_add_u32 s48, s48, s49
    v_lshrrev_b32 v20, 5, v0
    v_lshlrev_b32 v20, 3, v20
    v_and_b32 v21, 3, v0
    v_add_u32 v20, v20, v21
    v_add_u32 v20, s48, v20
    v_lshlrev_b32 v39, 1, v20
    v_cmp_le_u32 vcc, 5, v7
    v_subrev_u32 v20, 5, v7
    v_mov_b32 v21, 16
    v_cndmask_b32 v20, v7, v20, vcc
    v_cndmask_b32 v21, 0, v21, vcc
    v_lshl_add_u32 v20, v20, 7, v21
    v_lshl_add_u32 v20, v6, 5, v20
    s_mul_i32 s48, s58, 5120
    s_mul_i32 s49, s36, 640
    s_add_u32 s48, s48, s49
    s_add_u32 s48, s48, 1048576
    v_add_u32 v30, s48, v20
    v_mov_b32 v58, s39
    s_lshl_b32 s48, s36, 3
    v_mov_b32 v246, s48
    s_mov_b32 s60, 0x22222222
    s_mov_b32 s61, 0x22222222
    s_mov_b32 s62, 0x44444444
    s_mov_b32 s63, 0x44444444
    s_mov_b32 s96, 0x88888888
    s_mov_b32 s97, 0x88888888
    s_mov_b32 s98, 0x210021
    s_mov_b32 s99, 0x210021
    s_mov_b32 s100, 0x420042
    s_mov_b32 s101, 0x420042
    s_mov_b32 s4, 0x840084
    s_mov_b32 s5, 0x840084
    s_mov_b32 s6, 0x1080108
    s_mov_b32 s7, 0x1080108
    s_mov_b32 s56, 0x2100210
    s_mov_b32 s57, 0x2100210
    s_mov_b32 s40, 0x3e003e0
    s_mov_b32 s41, 0x3e003e0
    s_mov_b32 s51, 0
    v_mov_b32 v20, 9520
    v_add_u32 v21, 7168, v31
    v_cndmask_b32 v8, v20, v21, s[98:99]
    v_cndmask_b32 v9, v20, v21, s[100:101]
    v_cndmask_b32 v10, v20, v21, s[4:5]
    v_cndmask_b32 v11, v20, v21, s[6:7]
    v_cndmask_b32 v14, v20, v21, s[56:57]
    s_cmp_eq_u32 s36, 5
    s_cbranch_scc0 L_m3_nz
    v_mov_b32 v20, 0
    v_mov_b32 v21, 0
    v_mov_b32 v22, 0
    v_mov_b32 v23, 0
    s_mov_b64 exec, 1
    ds_write_b128 v1, v[20:23] offset:9520
    s_mov_b64 exec, -1
    s_waitcnt lgkmcnt(0)
L_m3_nz:
    s_waitcnt vmcnt(0)
    s_barrier
    v_lshlrev_b32 v241, 16, v241
    ds_read_b64_tr_b16 v[224:225], v26
    ds_read_b64_tr_b16 v[226:227], v26 offset:20480
    ds_read_b64_tr_b16 v[228:229], v27
    ds_read_b64_tr_b16 v[230:231], v27 offset:20480
    ds_read_b64_tr_b16 v[232:233], v28
    ds_read_b64_tr_b16 v[234:235], v28 offset:20480
    ds_read_b64_tr_b16 v[236:237], v37
    ds_read_b64_tr_b16 v[238:239], v37 offset:20480
    ds_read_b64_tr_b16 v[32:33], v38
    ds_read_b64_tr_b16 v[34:35], v38 offset:20480
    v_readfirstlane_b32 s53, v241
    s_cmp_lt_u32 s36, 4
    s_cbranch_scc0 L_m2_nw
    ds_read_b64_tr_b16 v[64:65], v24 offset:0
    ds_read_b64_tr_b16 v[66:67], v24 offset:2048
    ds_read_b64_tr_b16 v[68:69], v24 offset:4096
    ds_read_b64_tr_b16 v[70:71], v24 offset:6144
    ds_read_b64_tr_b16 v[72:73], v24 offset:8192
    ds_read_b64_tr_b16 v[74:75], v24 offset:10240
    ds_read_b64_tr_b16 v[76:77], v24 offset:12288
    ds_read_b64_tr_b16 v[78:79], v24 offset:14336
    ds_read_b64_tr_b16 v[80:81], v24 offset:16384
    ds_read_b64_tr_b16 v[82:83], v24 offset:18432
    ds_read_b64_tr_b16 v[84:85], v24 offset:20480
    ds_read_b64_tr_b16 v[86:87], v24 offset:22528
    ds_read_b64_tr_b16 v[88:89], v24 offset:24576
    ds_read_b64_tr_b16 v[90:91], v24 offset:26624
    ds_read_b64_tr_b16 v[92:93], v24 offset:28672
    ds_read_b64_tr_b16 v[94:95], v24 offset:30720
    ds_read_b64_tr_b16 v[96:97], v24 offset:32768
    ds_read_b64_tr_b16 v[98:99], v24 offset:34816
    ds_read_b64_tr_b16 v[100:101], v24 offset:36864
    ds_read_b64_tr_b16 v[102:103], v24 offset:38912
    ds_read_b64_tr_b16 v[104:105], v25 offset:0
    ds_read_b64_tr_b16 v[106:107], v25 offset:2048
    ds_read_b64_tr_b16 v[108:109], v25 offset:4096
    ds_read_b64_tr_b16 v[110:111], v25 offset:6144
    ds_read_b64_tr_b16 v[112:113], v25 offset:8192
    ds_read_b64_tr_b16 v[114:115], v25 offset:10240
    ds_read_b64_tr_b16 v[116:117], v25 offset:12288
    ds_read_b64_tr_b16 v[118:119], v25 offset:14336
    ds_read_b64_tr_b16 v[120:121], v25 offset:16384
    ds_read_b64_tr_b16 v[122:123], v25 offset:18432
    ds_read_b64_tr_b16 v[124:125], v25 offset:20480
    ds_read_b64_tr_b16 v[126:127], v25 offset:22528
    ds_read_b64_tr_b16 v[128:129], v25 offset:24576
    ds_read_b64_tr_b16 v[130:131], v25 offset:26624
    ds_read_b64_tr_b16 v[132:133], v25 offset:28672
    ds_read_b64_tr_b16 v[134:135], v25 offset:30720
    ds_read_b64_tr_b16 v[136:137], v25 offset:32768
    ds_read_b64_tr_b16 v[138:139], v25 offset:34816
    ds_read_b64_tr_b16 v[140:141], v25 offset:36864
    ds_read_b64_tr_b16 v[142:143], v25 offset:38912
    v_mov_b32 v48, 0x3f803f80
    v_mov_b32 v49, 0x3f803f80
    v_mov_b32 v50, 0x3f803f80
    v_mov_b32 v51, 0x3f803f80
    s_waitcnt lgkmcnt(0)
    v_mfma_f32_16x16x32_bf16 v[44:47], v[64:67], v[48:51], 0
    v_mfma_f32_16x16x32_bf16 v[44:47], v[68:71], v[48:51], v[44:47]
    v_mfma_f32_16x16x32_bf16 v[44:47], v[72:75], v[48:51], v[44:47]
    v_mfma_f32_16x16x32_bf16 v[44:47], v[76:79], v[48:51], v[44:47]
    v_mfma_f32_16x16x32_bf16 v[44:47], v[80:83], v[48:51], v[44:47]
    v_mfma_f32_16x16x32_bf16 v[44:47], v[84:87], v[48:51], v[44:47]
    v_mfma_f32_16x16x32_bf16 v[44:47], v[88:91], v[48:51], v[44:47]
    v_mfma_f32_16x16x32_bf16 v[44:47], v[92:95], v[48:51], v[44:47]
    v_mfma_f32_16x16x32_bf16 v[44:47], v[96:99], v[48:51], v[44:47]
    v_mfma_f32_16x16x32_bf16 v[44:47], v[100:103], v[48:51], v[44:47]
    v_mfma_f32_16x16x32_bf16 v[44:47], v[104:107], v[48:51], v[44:47]
    v_mfma_f32_16x16x32_bf16 v[44:47], v[108:111], v[48:51], v[44:47]
    v_mfma_f32_16x16x32_bf16 v[44:47], v[112:115], v[48:51], v[44:47]
    v_mfma_f32_16x16x32_bf16 v[44:47], v[116:119], v[48:51], v[44:47]
    v_mfma_f32_16x16x32_bf16 v[44:47], v[120:123], v[48:51], v[44:47]
    v_mfma_f32_16x16x32_bf16 v[44:47], v[124:127], v[48:51], v[44:47]
    v_mfma_f32_16x16x32_bf16 v[44:47], v[128:131], v[48:51], v[44:47]
    v_mfma_f32_16x16x32_bf16 v[44:47], v[132:135], v[48:51], v[44:47]
    v_mfma_f32_16x16x32_bf16 v[44:47], v[136:139], v[48:51], v[44:47]
    v_mfma_f32_16x16x32_bf16 v[44:47], v[140:143], v[48:51], v[44:47]
    s_nop 7
    v_cndmask_b32 v36, v44, v45, s[60:61]
    v_cndmask_b32 v36, v36, v46, s[62:63]
    v_cndmask_b32 v36, v36, v47, s[96:97]
L_m2_nw:
    s_cmp_lt_u32 s36, 5
    s_cbranch_scc0 L_m2_b1
    s_lshl_b32 s48, s36, 9
    s_add_u32 s48, s48, 950272
    v_lshrrev_b32 v247, 5, v0
    v_mul_u32_u24 v247, 2560, v247
    v_and_b32 v248, 31, v0
    v_lshl_add_u32 v247, v248, 4, v247
    v_add_u32 v247, s48, v247
    v_add_u32 v248, 5120, v247
    v_add_u32 v249, 10240, v247
    v_add_u32 v250, 15360, v247
    v_lshlrev_b32 v242, 16, v240
    v_and_b32 v243, 0xffff0000, v240
    s_mov_b32 s50, 0
    global_load_dwordx4 v[160:163], v247, s[32:33] sc1
    global_load_dwordx4 v[164:167], v248, s[32:33] sc1
    global_load_dwordx4 v[168:171], v249, s[32:33] sc1
    global_load_dwordx4 v[172:175], v250, s[32:33] sc1
outp_top_51:
    s_waitcnt vmcnt(0)
    v_cmp_ne_u32 s[10:11], s39, v163
    v_cmp_ne_u32 s[12:13], s39, v167
    v_cmp_ne_u32 s[14:15], s39, v171
    v_cmp_ne_u32 s[16:17], s39, v175
    s_or_b64 s[46:47], s[10:11], s[12:13]
    s_or_b64 s[46:47], s[46:47], s[14:15]
    s_or_b64 s[46:47], s[46:47], s[16:17]
    s_cbranch_scc1 outp_retry_53
outp_done_52:
    v_lshlrev_b32 v176, 16, v160
    v_and_b32 v177, 0xffff0000, v160
    v_lshlrev_b32 v178, 16, v161
    v_and_b32 v179, 0xffff0000, v161
    v_lshlrev_b32 v180, 16, v164
    v_and_b32 v181, 0xffff0000, v164
    v_lshlrev_b32 v182, 16, v165
    v_and_b32 v183, 0xffff0000, v165
    v_pk_add_f32 v[176:177], v[176:177], v[180:181]
    v_pk_add_f32 v[178:179], v[178:179], v[182:183]
    v_lshlrev_b32 v184, 16, v168
    v_and_b32 v185, 0xffff0000, v168
    v_lshlrev_b32 v186, 16, v169
    v_and_b32 v187, 0xffff0000, v169
    v_lshlrev_b32 v188, 16, v172
    v_and_b32 v189, 0xffff0000, v172
    v_lshlrev_b32 v190, 16, v173
    v_and_b32 v191, 0xffff0000, v173
    v_pk_add_f32 v[184:185], v[184:185], v[188:189]
    v_pk_add_f32 v[186:187], v[186:187], v[190:191]
    v_pk_add_f32 v[176:177], v[176:177], v[184:185]
    v_pk_add_f32 v[178:179], v[178:179], v[186:187]
    s_nop 0
    v_permlane32_swap_b32 v176, v178
    v_permlane32_swap_b32 v177, v179
    s_nop 0
    v_add_f32 v16, v176, v178
    v_add_f32 v17, v177, v179
    v_cvt_pk_bf16_f32 v16, v16, v17
    v_lshlrev_b32 v18, 16, v16
    v_and_b32 v19, 0xffff0000, v16
    v_pk_add_f32 v[18:19], v[18:19], v[242:243]
    v_cvt_pk_bf16_f32 v16, v18, v19
    ds_write_b32 v245, v16 offset:8192
    v_lshlrev_b32 v18, 16, v16
    v_and_b32 v19, 0xffff0000, v16
    v_subrev_f32 v18, s53, v18
    v_subrev_f32 v19, s53, v19
    v_add_f32 v160, v18, v19
    v_mul_f32 v161, v18, v18
    v_fmac_f32 v161, v19, v19
    s_nop 1
    v_add_f32_dpp v160, v160, v160 quad_perm:[1,0,3,2] row_mask:0xf bank_mask:0xf
    v_add_f32_dpp v161, v161, v161 quad_perm:[1,0,3,2] row_mask:0xf bank_mask:0xf
    s_nop 0
    v_add_f32_dpp v160, v160, v160 quad_perm:[2,3,0,1] row_mask:0xf bank_mask:0xf
    v_add_f32_dpp v161, v161, v161 quad_perm:[2,3,0,1] row_mask:0xf bank_mask:0xf
    s_nop 0
    v_add_f32_dpp v160, v160, v160 row_half_mirror row_mask:0xf bank_mask:0xf
    v_add_f32_dpp v161, v161, v161 row_half_mirror row_mask:0xf bank_mask:0xf
    s_nop 0
    v_add_f32_dpp v160, v160, v160 row_mirror row_mask:0xf bank_mask:0xf
    v_add_f32_dpp v161, v161, v161 row_mirror row_mask:0xf bank_mask:0xf
    s_nop 0
    v_mov_b32 v162, v160
    v_mov_b32 v163, v161
    s_nop 0
    v_permlane16_swap_b32 v162, v160
    v_permlane16_swap_b32 v163, v161
    v_add_f32 v160, v160, v162
    v_add_f32 v161, v161, v163
    v_mov_b32 v162, v160
    v_mov_b32 v163, v161
    s_nop 0
    v_permlane32_swap_b32 v162, v160
    v_permlane32_swap_b32 v163, v161
    v_add_f32 v160, v160, v162
    v_add_f32 v161, v161, v163
    s_mov_b64 exec, 1
    ds_write_b64 v246, v[160:161] offset:9472
    s_mov_b64 exec, -1
    s_waitcnt lgkmcnt(0)
L_m2_b1:
    s_mov_b32 s52, 0x3acccccd
    s_barrier
    s_cmp_lt_u32 s36, 4
    s_cbranch_scc0 L_m2_b3
    ds_read_b128 v[144:147], v31 offset:8192
    ds_read_b128 v[148:151], v31 offset:8256
    ds_read_b128 v[152:155], v31 offset:8320
    ds_read_b128 v[156:159], v31 offset:8384
    ds_read_b128 v[160:163], v31 offset:8448
    ds_read_b128 v[164:167], v31 offset:8512
    ds_read_b128 v[168:171], v31 offset:8576
    ds_read_b128 v[172:175], v31 offset:8640
    ds_read_b128 v[176:179], v31 offset:8704
    ds_read_b128 v[180:183], v31 offset:8768
    ds_read_b128 v[48:51], v1 offset:9472
    ds_read_b128 v[52:55], v1 offset:9488
    ds_read_b64 v[56:57], v1 offset:9504
    s_waitcnt lgkmcnt(12)
    v_mfma_f32_16x16x32_bf16 v[40:43], v[64:67], v[144:147], 0
    ds_read_b128 v[184:187], v31 offset:8832
    s_waitcnt lgkmcnt(12)
    v_mfma_f32_16x16x32_bf16 v[44:47], v[68:71], v[148:151], 0
    ds_read_b128 v[188:191], v31 offset:8896
    s_waitcnt lgkmcnt(12)
    v_mfma_f32_16x16x32_bf16 v[40:43], v[72:75], v[152:155], v[40:43]
    ds_read_b128 v[192:195], v31 offset:8960
    s_waitcnt lgkmcnt(12)
    v_mfma_f32_16x16x32_bf16 v[44:47], v[76:79], v[156:159], v[44:47]
    ds_read_b128 v[196:199], v31 offset:9024
    s_waitcnt lgkmcnt(4)
    v_mfma_f32_16x16x32_bf16 v[40:43], v[80:83], v[160:163], v[40:43]
    ds_read_b128 v[200:203], v31 offset:9088
    v_pk_add_f32 v[48:49], v[48:49], v[50:51]
    v_mfma_f32_16x16x32_bf16 v[44:47], v[84:87], v[164:167], v[44:47]
    ds_read_b128 v[204:207], v31 offset:9152
    v_pk_add_f32 v[52:53], v[52:53], v[54:55]
    s_waitcnt lgkmcnt(11)
    v_mfma_f32_16x16x32_bf16 v[40:43], v[88:91], v[168:171], v[40:43]
    ds_read_b128 v[208:211], v31 offset:9216
    v_pk_add_f32 v[48:49], v[48:49], v[56:57]
    v_mfma_f32_16x16x32_bf16 v[44:47], v[92:95], v[172:175], v[44:47]
    ds_read_b128 v[212:215], v31 offset:9280
    v_pk_add_f32 v[48:49], v[48:49], v[52:53]
    s_waitcnt lgkmcnt(11)
    v_mfma_f32_16x16x32_bf16 v[40:43], v[96:99], v[176:179], v[40:43]
    ds_read_b128 v[216:219], v31 offset:9344
    s_mov_b32 s52, 0x3acccccd
    v_mfma_f32_16x16x32_bf16 v[44:47], v[100:103], v[180:183], v[44:47]
    ds_read_b128 v[220:223], v31 offset:9408
    v_mul_f32 v48, s52, v48
    s_waitcnt lgkmcnt(8)
    v_mfma_f32_16x16x32_bf16 v[40:43], v[104:107], v[184:187], v[40:43]
    v_mul_f32 v49, s52, v49
    v_fma_f32 v49, -v48, v48, v49
    v_mfma_f32_16x16x32_bf16 v[44:47], v[108:111], v[188:191], v[44:47]
    v_max_f32 v49, 0, v49
    v_add_f32 v50, s53, v48
    s_waitcnt lgkmcnt(6)
    v_mfma_f32_16x16x32_bf16 v[40:43], v[112:115], v[192:195], v[40:43]
    v_cvt_pk_bf16_f32 v50, v50, v50
    v_and_b32 v50, 0xffff0000, v50
    v_mfma_f32_16x16x32_bf16 v[44:47], v[116:119], v[196:199], v[44:47]
    v_cvt_pk_bf16_f32 v49, v49, v49
    v_and_b32 v49, 0xffff0000, v49
    s_waitcnt lgkmcnt(4)
    v_mfma_f32_16x16x32_bf16 v[40:43], v[120:123], v[200:203], v[40:43]
    v_add_f32 v49, 0x3727c5ac, v49
    v_cvt_pk_bf16_f32 v49, v49, v49
    v_mfma_f32_16x16x32_bf16 v[44:47], v[124:127], v[204:207], v[44:47]
    v_and_b32 v49, 0xffff0000, v49
    v_sqrt_f32 v49, v49
    s_waitcnt lgkmcnt(2)
    v_mfma_f32_16x16x32_bf16 v[40:43], v[128:131], v[208:211], v[40:43]
    v_cvt_pk_bf16_f32 v49, v49, v49
    v_and_b32 v49, 0xffff0000, v49
    v_mfma_f32_16x16x32_bf16 v[44:47], v[132:135], v[212:215], v[44:47]
    v_rcp_f32 v51, v49
    s_waitcnt lgkmcnt(0)
    v_mfma_f32_16x16x32_bf16 v[40:43], v[136:139], v[216:219], v[40:43]
    v_mul_f32 v50, v50, v36
    v_mfma_f32_16x16x32_bf16 v[44:47], v[140:143], v[220:223], v[44:47]
    s_nop 7
    v_pk_add_f32 v[40:41], v[40:41], v[44:45]
    v_pk_add_f32 v[42:43], v[42:43], v[46:47]
    v_cndmask_b32 v16, v40, v41, s[60:61]
    v_cndmask_b32 v16, v16, v42, s[62:63]
    v_cndmask_b32 v16, v16, v43, s[96:97]
    v_sub_f32 v16, v16, v50
    v_mul_f32 v16, v16, v51
    v_cvt_pk_bf16_f32 v16, v16, v16
    v_and_b32 v16, 0xffff0000, v16
    v_mov_b32 v17, v16
    s_nop 1
    v_permlane16_swap_b32 v16, v17
    s_nop 0
    v_max_f32 v16, 0, v16
    v_mul_f32 v16, v16, v17
    v_cvt_pk_bf16_f32 v16, v16, v16
    s_mov_b32 exec_lo, 0xf
    s_mov_b32 exec_hi, 0xf
    ds_write_b16 v39, v16 offset:7168
    s_mov_b64 exec, -1
    s_waitcnt lgkmcnt(0)
L_m2_b3:
    s_barrier
    ds_read_b128 v[144:147], v8
    ds_read_b128 v[148:151], v9
    ds_read_b128 v[152:155], v10
    ds_read_b128 v[156:159], v11
    ds_read_b128 v[160:163], v14
    s_waitcnt lgkmcnt(4)
    v_mfma_f32_16x16x32_bf16 v[40:43], v[224:227], v[144:147], 0
    s_waitcnt lgkmcnt(3)
    v_mfma_f32_16x16x32_bf16 v[40:43], v[228:231], v[148:151], v[40:43]
    s_waitcnt lgkmcnt(2)
    v_mfma_f32_16x16x32_bf16 v[40:43], v[232:235], v[152:155], v[40:43]
    s_waitcnt lgkmcnt(1)
    v_mfma_f32_16x16x32_bf16 v[40:43], v[236:239], v[156:159], v[40:43]
    s_waitcnt lgkmcnt(0)
    v_mfma_f32_16x16x32_bf16 v[40:43], v[32:35], v[160:163], v[40:43]
    s_mov_b32 exec_lo, 0x03ff03ff
    s_mov_b32 exec_hi, 0x03ff03ff
    s_nop 5
    v_cndmask_b32 v60, v40, v42, s[40:41]
    v_cndmask_b32 v61, v41, v43, s[40:41]
    global_store_dwordx4 v30, v[58:61], s[32:33] sc1
    s_mov_b64 exec, -1
    s_branch L_fin
L_fin:
L_fin2:
L_end:
    s_endpgm
qa_retry_8:
    s_add_u32 s50, s50, 1
    s_mov_b64 exec, s[10:11]
    s_cbranch_execz qa_sk_9
    global_load_dwordx4 v[16:19], v248, s[32:33] offset:0 sc1
qa_sk_9:
    s_mov_b64 exec, s[12:13]
    s_cbranch_execz qa_sk_10
    global_load_dwordx4 v[20:23], v248, s[32:33] offset:1024 sc1
qa_sk_10:
    s_mov_b64 exec, s[14:15]
    s_cbranch_execz qa_sk_11
    global_load_dwordx4 v[24:27], v248, s[32:33] offset:2048 sc1
qa_sk_11:
    s_mov_b64 exec, s[18:19]
    s_cbranch_execz qa_sk_12
    global_load_dwordx4 v[28:31], v248, s[32:33] offset:3072 sc1
qa_sk_12:
    s_mov_b64 exec, -1
    s_cmp_lt_u32 s50, 131072
    s_cbranch_scc1 qa_top_6
    s_waitcnt vmcnt(0)
    s_mov_b64 exec, 1
    v_mov_b32 v10, 48
    v_mov_b32 v11, 4108
    global_store_dword v10, v11, s[30:31]
    s_mov_b64 exec, -1
    s_branch qa_done_7
L_a_v:
    s_and_b32 s49, s36, 3
    s_lshl_b32 s49, s49, 13
    s_add_u32 m0, s49, 59392
    s_nop 0
    global_load_lds_dwordx4 v41, s[98:99]
    s_add_u32 m0, m0, 1024
    s_add_u32 s98, s98, 8192
    s_addc_u32 s99, s99, 0
    global_load_lds_dwordx4 v41, s[98:99]
    s_add_u32 m0, m0, 1024
    s_add_u32 s98, s98, 8192
    s_addc_u32 s99, s99, 0
    global_load_lds_dwordx4 v41, s[98:99]
    s_add_u32 m0, m0, 1024
    s_add_u32 s98, s98, 8192
    s_addc_u32 s99, s99, 0
    global_load_lds_dwordx4 v41, s[98:99]
    s_add_u32 m0, m0, 1024
    s_add_u32 s98, s98, 8192
    s_addc_u32 s99, s99, 0
    global_load_lds_dwordx4 v41, s[98:99]
    s_add_u32 m0, m0, 1024
    s_add_u32 s98, s98, 8192
    s_addc_u32 s99, s99, 0
    global_load_lds_dwordx4 v41, s[98:99]
    s_add_u32 m0, m0, 1024
    s_add_u32 s98, s98, 8192
    s_addc_u32 s99, s99, 0
    global_load_lds_dwordx4 v41, s[98:99]
    s_add_u32 m0, m0, 1024
    s_add_u32 s98, s98, 8192
    s_addc_u32 s99, s99, 0
    global_load_lds_dwordx4 v41, s[98:99]
    s_barrier
    s_waitcnt vmcnt(0)
    s_barrier
    ds_read_b64_tr_b16 v[96:97], v40 offset:0
    ds_read_b64_tr_b16 v[98:99], v40 offset:2048
    ds_read_b64_tr_b16 v[100:101], v40 offset:4096
    ds_read_b64_tr_b16 v[102:103], v40 offset:6144
    ds_read_b64_tr_b16 v[104:105], v40 offset:8192
    ds_read_b64_tr_b16 v[106:107], v40 offset:10240
    ds_read_b64_tr_b16 v[108:109], v40 offset:12288
    ds_read_b64_tr_b16 v[110:111], v40 offset:14336
    ds_read_b64_tr_b16 v[112:113], v40 offset:16384
    ds_read_b64_tr_b16 v[114:115], v40 offset:18432
    ds_read_b64_tr_b16 v[116:117], v40 offset:20480
    ds_read_b64_tr_b16 v[118:119], v40 offset:22528
    ds_read_b64_tr_b16 v[120:121], v40 offset:24576
    ds_read_b64_tr_b16 v[122:123], v40 offset:26624
    ds_read_b64_tr_b16 v[124:125], v40 offset:28672
    ds_read_b64_tr_b16 v[126:127], v40 offset:30720
    ds_read_b64_tr_b16 v[128:129], v40 offset:32768
    ds_read_b64_tr_b16 v[130:131], v40 offset:34816
    ds_read_b64_tr_b16 v[132:133], v40 offset:36864
    ds_read_b64_tr_b16 v[134:135], v40 offset:38912
    ds_read_b64_tr_b16 v[136:137], v40 offset:40960
    ds_read_b64_tr_b16 v[138:139], v40 offset:43008
    ds_read_b64_tr_b16 v[140:141], v40 offset:45056
    ds_read_b64_tr_b16 v[142:143], v40 offset:47104
    ds_read_b64_tr_b16 v[144:145], v40 offset:49152
    ds_read_b64_tr_b16 v[146:147], v40 offset:51200
    ds_read_b64_tr_b16 v[148:149], v40 offset:53248
    ds_read_b64_tr_b16 v[150:151], v40 offset:55296
    ds_read_b64_tr_b16 v[152:153], v40 offset:57344
    ds_read_b64_tr_b16 v[154:155], v40 offset:59392
    ds_read_b64_tr_b16 v[156:157], v40 offset:61440
    ds_read_b64_tr_b16 v[158:159], v40 offset:63488
    v_mov_b32 v51, s39
    s_branch L_a_px
ms_slow_13:
    global_store_dwordx4 v58, v[60:63], s[32:33] sc1
    s_branch ms_done_14
px_retry_17:
    s_add_u32 s50, s50, 1
    s_mov_b64 exec, s[10:11]
    s_cbranch_execz px_sk_18
    global_load_dwordx4 v[16:19], v246, s[32:33] offset:0 sc1
px_sk_18:
    s_mov_b64 exec, s[12:13]
    s_cbranch_execz px_sk_19
    global_load_dwordx4 v[20:23], v246, s[32:33] offset:1024 sc1
px_sk_19:
    s_mov_b64 exec, s[14:15]
    s_cbranch_execz px_sk_20
    global_load_dwordx4 v[24:27], v246, s[32:33] offset:2048 sc1
px_sk_20:
    s_mov_b64 exec, s[18:19]
    s_cbranch_execz px_sk_21
    global_load_dwordx4 v[28:31], v246, s[32:33] offset:3072 sc1
px_sk_21:
    s_mov_b64 exec, -1
    s_cmp_lt_u32 s50, 131072
    s_cbranch_scc1 px_top_15
    s_waitcnt vmcnt(0)
    s_mov_b64 exec, 1
    v_mov_b32 v10, 84
    v_mov_b32 v11, 4117
    global_store_dword v10, v11, s[30:31]
    s_mov_b64 exec, -1
    s_branch px_done_16
L_a_lw:
    s_cmp_eq_u32 s36, 0
    s_cbranch_scc0 L_a_w2
    s_cmp_eq_u32 s58, 0
    s_cbranch_scc0 L_a_w2
    ds_read_b128 v[32:35], v43
    ds_read_b128 v[36:39], v43 offset:16
    ds_read_b128 v[160:163], v42 offset:0
    ds_read_b128 v[164:167], v42 offset:1024
    ds_read_b128 v[168:171], v42 offset:2048
    ds_read_b128 v[172:175], v42 offset:3072
    ds_read_b128 v[176:179], v42 offset:4096
    ds_read_b128 v[180:183], v42 offset:5120
    ds_read_b128 v[184:187], v42 offset:6144
    ds_read_b128 v[188:191], v42 offset:7168
    ds_read_b128 v[192:195], v42 offset:8192
    ds_read_b128 v[196:199], v42 offset:9216
    ds_read_b128 v[200:203], v42 offset:10240
    ds_read_b128 v[204:207], v42 offset:11264
    v_mov_b32 v88, 0x3f803f80
    v_mov_b32 v89, 0x3f803f80
    v_mov_b32 v90, 0x3f803f80
    v_mov_b32 v91, 0x3f803f80
    s_waitcnt lgkmcnt(12)
    v_max3_f32 v20, v32, v33, v34
    v_max3_f32 v20, v20, v35, v36
    v_max3_f32 v20, v20, v37, v38
    v_max_f32 v20, v20, v39
    v_sub_f32 v32, v32, v20
    v_sub_f32 v33, v33, v20
    v_sub_f32 v34, v34, v20
    v_sub_f32 v35, v35, v20
    v_sub_f32 v36, v36, v20
    v_sub_f32 v37, v37, v20
    v_sub_f32 v38, v38, v20
    v_sub_f32 v39, v39, v20
    s_waitcnt lgkmcnt(10)
    v_mfma_f32_16x16x32_bf16 v[224:227], v[88:91], v[160:163], 0
    v_mfma_f32_16x16x32_bf16 v[224:227], v[88:91], v[164:167], v[224:227]
    ds_read_b128 v[208:211], v42 offset:12288
    ds_read_b128 v[212:215], v42 offset:13312
    v_exp_f32 v32, v32
    s_waitcnt lgkmcnt(10)
    v_mfma_f32_16x16x32_bf16 v[228:231], v[88:91], v[168:171], 0
    v_mfma_f32_16x16x32_bf16 v[228:231], v[88:91], v[172:175], v[228:231]
    ds_read_b128 v[216:219], v42 offset:14336
    ds_read_b128 v[220:223], v42 offset:15360
    v_exp_f32 v33, v33
    s_waitcnt lgkmcnt(10)
    v_mfma_f32_16x16x32_bf16 v[232:235], v[88:91], v[176:179], 0
    v_mfma_f32_16x16x32_bf16 v[232:235], v[88:91], v[180:183], v[232:235]
    v_exp_f32 v34, v34
    v_mul_f32 v236, v224, v32
    s_nop 2
    s_waitcnt lgkmcnt(8)
    v_mfma_f32_16x16x32_bf16 v[224:227], v[88:91], v[184:187], 0
    v_mfma_f32_16x16x32_bf16 v[224:227], v[88:91], v[188:191], v[224:227]
    v_exp_f32 v35, v35
    v_fma_f32 v236, v228, v33, v236
    s_nop 2
    s_waitcnt lgkmcnt(6)
    v_mfma_f32_16x16x32_bf16 v[228:231], v[88:91], v[192:195], 0
    v_mfma_f32_16x16x32_bf16 v[228:231], v[88:91], v[196:199], v[228:231]
    v_exp_f32 v36, v36
    v_fma_f32 v236, v232, v34, v236
    s_nop 2
    s_waitcnt lgkmcnt(4)
    v_mfma_f32_16x16x32_bf16 v[232:235], v[88:91], v[200:203], 0
    v_mfma_f32_16x16x32_bf16 v[232:235], v[88:91], v[204:207], v[232:235]
    v_exp_f32 v37, v37
    v_fma_f32 v236, v224, v35, v236
    s_nop 2
    s_waitcnt lgkmcnt(2)
    v_mfma_f32_16x16x32_bf16 v[224:227], v[88:91], v[208:211], 0
    v_mfma_f32_16x16x32_bf16 v[224:227], v[88:91], v[212:215], v[224:227]
    v_exp_f32 v38, v38
    v_fma_f32 v236, v228, v36, v236
    s_nop 2
    s_waitcnt lgkmcnt(0)
    v_mfma_f32_16x16x32_bf16 v[228:231], v[88:91], v[216:219], 0
    v_mfma_f32_16x16x32_bf16 v[228:231], v[88:91], v[220:223], v[228:231]
    v_exp_f32 v39, v39
    v_fma_f32 v236, v232, v37, v236
    s_nop 2
    s_nop 3
    v_fma_f32 v236, v224, v38, v236
    s_nop 3
    v_fma_f32 v236, v228, v39, v236
    v_mov_b32 v21, v236
    v_mov_b32 v23, s39
    s_mov_b32 exec_lo, 0xffff
    s_mov_b32 exec_hi, 0x0
    global_store_dwordx4 v250, v[20:23], s[32:33] sc1
    s_mov_b64 exec, -1
L_a_w2:
    s_branch L_a_s4
ox_retry_24:
    s_add_u32 s50, s50, 1
    s_mov_b64 exec, s[10:11]
    global_load_dwordx4 v[16:19], v245, s[32:33] sc1
    s_mov_b64 exec, -1
    s_cmp_lt_u32 s50, 131072
    s_cbranch_scc1 ox_top_22
    s_waitcnt vmcnt(0)
    s_mov_b64 exec, 1
    v_mov_b32 v10, 96
    v_mov_b32 v11, 4120
    global_store_dword v10, v11, s[30:31]
    s_mov_b64 exec, -1
    s_branch ox_done_23
ms_slow_25:
    global_store_dwordx4 v253, v[20:23], s[32:33] sc1
    s_branch ms_done_26
hf_retry_29:
    s_add_u32 s50, s50, 1
    s_mov_b64 exec, s[10:11]
    global_load_dwordx4 v[16:19], v9, s[32:33] sc1
    s_mov_b64 exec, -1
    s_cmp_lt_u32 s50, 131072
    s_cbranch_scc1 hf_top_27
    s_waitcnt vmcnt(0)
    s_mov_b64 exec, 1
    v_mov_b32 v10, 116
    v_mov_b32 v11, 4125
    global_store_dword v10, v11, s[30:31]
    s_mov_b64 exec, -1
    s_branch hf_done_28
o2_retry_32:
    s_add_u32 s50, s50, 1
    s_mov_b64 exec, s[10:11]
    s_cbranch_execz o2_sk_33
    global_load_dwordx4 v[32:35], v12, s[32:33] sc1
o2_sk_33:
    s_mov_b64 exec, s[12:13]
    s_cbranch_execz o2_sk_34
    global_load_dwordx4 v[36:39], v13, s[32:33] sc1
o2_sk_34:
    s_mov_b64 exec, s[14:15]
    s_cbranch_execz o2_sk_35
    global_load_dwordx4 v[40:43], v14, s[32:33] sc1
o2_sk_35:
    s_mov_b64 exec, s[18:19]
    s_cbranch_execz o2_sk_36
    global_load_dwordx4 v[44:47], v15, s[32:33] sc1
o2_sk_36:
    s_mov_b64 exec, -1
    s_cmp_lt_u32 s50, 131072
    s_cbranch_scc1 o2_top_30
    s_waitcnt vmcnt(0)
    s_mov_b64 exec, 1
    v_mov_b32 v10, 144
    v_mov_b32 v11, 4132
    global_store_dword v10, v11, s[30:31]
    s_mov_b64 exec, -1
    s_branch o2_done_31
q1_retry_39:
    s_add_u32 s50, s50, 1
    s_and_b32 s51, s50, 7
    s_cmp_eq_u32 s51, 0
    s_cselect_b64 s[44:45], s[42:43], s[40:41]
    s_mov_b64 exec, s[10:11]
    s_cbranch_execz q1_sk_40
    global_load_dwordx4 v[32:35], v3, s[44:45] offset:0 sc1
q1_sk_40:
    s_mov_b64 exec, s[12:13]
    s_cbranch_execz q1_sk_41
    global_load_dwordx4 v[36:39], v3, s[44:45] offset:1024 sc1
q1_sk_41:
    s_mov_b64 exec, s[14:15]
    s_cbranch_execz q1_sk_42
    global_load_dwordx4 v[40:43], v3, s[44:45] offset:2048 sc1
q1_sk_42:
    s_mov_b64 exec, s[4:5]
    s_cbranch_execz q1_sk_43
    global_load_dwordx4 v[44:47], v3, s[44:45] offset:3072 sc1
q1_sk_43:
    s_mov_b64 exec, s[20:21]
    s_cbranch_execz q1_sk_44
    global_load_dwordx4 v[48:51], v4, s[44:45] offset:0 sc1
q1_sk_44:
    s_mov_b64 exec, s[96:97]
    s_cbranch_execz q1_sk_45
    global_load_dwordx4 v[52:55], v4, s[44:45] offset:1024 sc1
q1_sk_45:
    s_mov_b64 exec, s[98:99]
    s_cbranch_execz q1_sk_46
    global_load_dwordx4 v[56:59], v4, s[44:45] offset:2048 sc1
q1_sk_46:
    s_mov_b64 exec, s[100:101]
    s_cbranch_execz q1_sk_47
    global_load_dwordx4 v[60:63], v4, s[44:45] offset:3072 sc1
q1_sk_47:
    s_mov_b64 exec, -1
    s_cmp_lt_u32 s50, 131072
    s_cbranch_scc1 q1_top_37
    s_waitcnt vmcnt(0)
    s_mov_b64 exec, 1
    v_mov_b32 v10, 188
    v_mov_b32 v11, 4143
    global_store_dword v10, v11, s[30:31]
    s_mov_b64 exec, -1
    s_branch q1_done_38
L_b1x:
    s_barrier
    s_branch L_b2
c4_retry_50:
    s_add_u32 s50, s50, 1
    s_mov_b64 exec, s[10:11]
    global_load_dwordx4 v[16:19], v11, s[32:33] sc1
    s_mov_b64 exec, -1
    s_cmp_lt_u32 s50, 131072
    s_cbranch_scc1 c4_top_48
    s_waitcnt vmcnt(0)
    s_mov_b64 exec, 1
    v_mov_b32 v13, 200
    v_mov_b32 v14, 4146
    global_store_dword v13, v14, s[30:31]
    s_mov_b64 exec, -1
    s_branch c4_done_49
outp_retry_53:
    s_add_u32 s50, s50, 1
    s_mov_b64 exec, s[10:11]
    s_cbranch_execz outp_sk_54
    global_load_dwordx4 v[160:163], v247, s[32:33] sc1
outp_sk_54:
    s_mov_b64 exec, s[12:13]
    s_cbranch_execz outp_sk_55
    global_load_dwordx4 v[164:167], v248, s[32:33] sc1
outp_sk_55:
    s_mov_b64 exec, s[14:15]
    s_cbranch_execz outp_sk_56
    global_load_dwordx4 v[168:171], v249, s[32:33] sc1
outp_sk_56:
    s_mov_b64 exec, s[16:17]
    s_cbranch_execz outp_sk_57
    global_load_dwordx4 v[172:175], v250, s[32:33] sc1
outp_sk_57:
    s_mov_b64 exec, -1
    s_cmp_lt_u32 s50, 131072
    s_cbranch_scc1 outp_top_51
    s_waitcnt vmcnt(0)
    s_mov_b64 exec, 1
    v_mov_b32 v12, 228
    v_mov_b32 v13, 4153
    global_store_dword v12, v13, s[30:31]
    s_mov_b64 exec, -1
    s_branch outp_done_52
L_codeend:
.section .rodata,"a"
.p2align 6
.amdhsa_kernel sequential_preLN__compressed_kv_cla__glu_gated_reglu__decode_kernel
  .amdhsa_next_free_vgpr 256
  .amdhsa_next_free_sgpr 102
  .amdhsa_accum_offset 256
  .amdhsa_group_segment_fixed_size 0
  .amdhsa_kernarg_size 104
  .amdhsa_user_sgpr_count 2
  .amdhsa_user_sgpr_kernarg_segment_ptr 1
  .amdhsa_system_sgpr_workgroup_id_x 1
.end_amdhsa_kernel
```
